```python
import torch

def _softmax(x, axis=-1):
    return torch.softmax(x, dim=axis)
def _gelu(x):
    return torch.nn.functional.gelu(x, approximate="tanh")
def _silu(x):
    return torch.nn.functional.silu(x)
def _sigmoid(x):
    return torch.sigmoid(x)
def _layernorm(x, axis=-1, eps=1e-5):
    m = x.mean(dim=axis, keepdim=True)
    v = x.var(dim=axis, keepdim=True, unbiased=False)
    return (x - m) / torch.sqrt(v + eps)
def _scatter_add(tgt, idx, src, axis=0):
    return tgt.clone().index_add_(axis, idx, src)
def _segment_sum(src, seg, n):
    out = torch.zeros((n,) + src.shape[1:], dtype=src.dtype)
    return out.index_add_(0, seg, src)
def _pad(x, pw):
    flat = tuple(v for pair in reversed(pw) for v in pair)
    return torch.nn.functional.pad(x, flat)

kernel_name = 'standalone__cross_network_dcn_v2__recsys'

def setup_inputs():

    _w = (lambda a: (lambda t: t.to(torch.bfloat16) if t.is_floating_point() else t)(torch.as_tensor(a)))
    B, F, D, L = 16384, 100, 32, 6
    Din = min(F * D, 512)
    R = max(Din // 4, 2)
    sc = Din ** -0.5
    return {
        "x0": _w((lambda *s: torch.randn(*s, dtype=torch.bfloat16) * 0.05)(B, Din)),
        "U":  _w((lambda *s: torch.randn(*s, dtype=torch.bfloat16) * 1.6)(L, Din, R) * sc),
        "V":  _w((lambda *s: torch.randn(*s, dtype=torch.bfloat16) * 1.6)(L, R, Din) * sc),
        "bs": _w((lambda *s: torch.randn(*s, dtype=torch.bfloat16) * 0.05)(L, Din)),
    }

def reference(x0, U, V, bs):
    x = x0
    for l in range(U.shape[0]):
        h = torch.einsum('rd,bd->br', V[l], x)
        h = torch.einsum('dr,br->bd', U[l], h)
        x = x0 * (h + bs[l]) + x
    return x
```

```asm
; @launch grid=(256,1,1) block=(256,1,1) lds=146496
.amdgcn_target "amdgcn-amd-amdhsa--gfx950"
.text

.globl standalone__cross_network_dcn_v2__recsys_kernel
.p2align 8
.type standalone__cross_network_dcn_v2__recsys_kernel,@function
standalone__cross_network_dcn_v2__recsys_kernel:
    s_cmp_ge_u32 s2, 256
    s_cbranch_scc1 L_done
    s_load_dwordx8 s[24:31], s[0:1], 0
    s_load_dwordx4 s[32:35], s[0:1], 32
    s_load_dwordx2 s[36:37], s[0:1], 48
    v_lshrrev_b32 v96, 6, v0
    v_and_b32 v97, 63, v0
    v_readfirstlane_b32 s20, v96
    v_and_b32 v98, 15, v97
    v_lshrrev_b32 v99, 4, v97
    v_lshlrev_b32 v101, 4, v97
    v_mov_b32 v15, 0
    s_lshr_b32 s76, s2, 3
    s_lshl_b32 s77, s20, 15
    s_mul_i32 s59, s20, 33280
    s_add_u32 s59, s59, 0
    s_waitcnt lgkmcnt(0)
    s_mov_b32 s4, s24
    s_and_b32 s5, s25, 0xffff
    s_mov_b32 s6, 16777216
    s_mov_b32 s7, 0x00020000
    s_mov_b32 s48, s28
    s_and_b32 s49, s29, 0xffff
    s_mov_b32 s50, 786432
    s_mov_b32 s51, 0x00020000
    s_cmp_lg_u32 s20, 3
    s_cbranch_scc1 L_w012
    s_setprio 3
    s_mov_b32 s44, s26
    s_and_b32 s45, s27, 0xffff
    s_mov_b32 s46, 786432
    s_mov_b32 s47, 0x00020000
    s_mov_b32 s16, s30
    s_and_b32 s17, s31, 0xffff
    s_mov_b32 s18, 6144
    s_mov_b32 s19, 0x00020000
    s_mov_b32 s12, s32
    s_and_b32 s13, s33, 0xffff
    s_mov_b32 s14, 16777216
    s_mov_b32 s15, 0x00020000
    s_mov_b32 s52, s34
    s_and_b32 s53, s35, 0xffff
    s_mov_b32 s54, 256
    s_mov_b32 s55, 0x00020000
    s_mov_b32 s8, s36
    s_and_b32 s9, s37, 0xffff
    s_mov_b32 s10, 1576960
    s_mov_b32 s11, 0x00020000
    s_cmp_lg_u32 s2, 0
    s_cbranch_scc1 L_nonon
    s_memrealtime s[60:61]
    s_waitcnt lgkmcnt(0)
    s_or_b32 s60, s60, 1
    v_mov_b32 v102, s60
    buffer_store_dword v102, v15, s[52:55], 0 offen sc0 sc1
    s_nop 1
L_nonon:
    s_sub_u32 s61, s2, 176
    s_cmp_lt_u32 s2, 176
    s_cselect_b32 s61, s2, s61
    s_and_b32 s63, s61, 3
    s_lshr_b32 s64, s61, 2
    s_mul_i32 s65, s63, 393216
    s_lshl_b32 s68, s64, 13
    s_add_u32 s70, s65, s68
    s_add_u32 s70, s70, 32768
    s_add_u32 s71, s70, 4096
    s_and_b32 s66, s64, 7
    s_lshr_b32 s65, s64, 3
    s_lshl_b32 s66, s66, 2
    s_lshr_b32 s66, 0x76534210, s66
    s_and_b32 s66, s66, 7
    s_cmp_eq_u32 s64, 43
    s_cselect_b32 s66, 3, s66
    s_and_b32 s68, s66, 3
    s_lshl_b32 s65, s65, 17
    s_lshl_b32 s69, s63, 15
    s_add_u32 s65, s65, s69
    s_bitcmp1_b32 s66, 2
    s_cbranch_scc1 L_shV
    s_lshl_b32 s68, s68, 13
    s_add_u32 s65, s65, s68
    s_mov_b32 m0, 133120
    s_add_u32 s67, s65, 0
    buffer_load_dwordx4 v101, s[44:47], s67 offen lds
    s_mov_b32 m0, 134160
    s_add_u32 s67, s65, 1024
    buffer_load_dwordx4 v101, s[44:47], s67 offen lds
    s_mov_b32 m0, 135200
    s_add_u32 s67, s65, 2048
    buffer_load_dwordx4 v101, s[44:47], s67 offen lds
    s_mov_b32 m0, 136240
    s_add_u32 s67, s65, 3072
    buffer_load_dwordx4 v101, s[44:47], s67 offen lds
    s_mov_b32 m0, 137280
    s_add_u32 s67, s65, 4096
    buffer_load_dwordx4 v101, s[44:47], s67 offen lds
    s_mov_b32 m0, 138320
    s_add_u32 s67, s65, 5120
    buffer_load_dwordx4 v101, s[44:47], s67 offen lds
    s_mov_b32 m0, 139360
    s_add_u32 s67, s65, 6144
    buffer_load_dwordx4 v101, s[44:47], s67 offen lds
    s_mov_b32 m0, 140400
    s_add_u32 s67, s65, 7168
    buffer_load_dwordx4 v101, s[44:47], s67 offen lds
    s_branch L_shN
L_shV:
    s_lshl_b32 s68, s68, 6
    s_add_u32 s65, s65, s68
    s_add_u32 s65, s65, 131072
    v_bfe_u32 v102, v97, 2, 2
    v_lshlrev_b32 v102, 8, v102
    v_lshl_add_u32 v102, v99, 10, v102
    v_and_b32 v103, 3, v97
    v_lshl_add_u32 v102, v103, 4, v102
    s_mov_b32 m0, 133120
    s_add_u32 s67, s65, 0
    buffer_load_dwordx4 v102, s[48:51], s67 offen lds
    s_mov_b32 m0, 134160
    s_add_u32 s67, s65, 4096
    buffer_load_dwordx4 v102, s[48:51], s67 offen lds
    s_mov_b32 m0, 135200
    s_add_u32 s67, s65, 8192
    buffer_load_dwordx4 v102, s[48:51], s67 offen lds
    s_mov_b32 m0, 136240
    s_add_u32 s67, s65, 12288
    buffer_load_dwordx4 v102, s[48:51], s67 offen lds
    s_mov_b32 m0, 137280
    s_add_u32 s67, s65, 16384
    buffer_load_dwordx4 v102, s[48:51], s67 offen lds
    s_mov_b32 m0, 138320
    s_add_u32 s67, s65, 20480
    buffer_load_dwordx4 v102, s[48:51], s67 offen lds
    s_mov_b32 m0, 139360
    s_add_u32 s67, s65, 24576
    buffer_load_dwordx4 v102, s[48:51], s67 offen lds
    s_mov_b32 m0, 140400
    s_add_u32 s67, s65, 28672
    buffer_load_dwordx4 v102, s[48:51], s67 offen lds
L_shN:
    s_movk_i32 s26, 4096
    buffer_load_dwordx4 v[128:131], v101, s[16:19], 0 offen offset:0
    buffer_load_dwordx4 v[132:135], v101, s[16:19], 0 offen offset:1024
    buffer_load_dwordx4 v[136:139], v101, s[16:19], 0 offen offset:2048
    buffer_load_dwordx4 v[140:143], v101, s[16:19], 0 offen offset:3072
    buffer_load_dwordx4 v[144:147], v101, s[16:19], s26 offen offset:0
    buffer_load_dwordx4 v[148:151], v101, s[16:19], s26 offen offset:1024
    s_add_u32 s78, s76, 0
    s_and_b32 s78, s78, 31
    s_mul_i32 s79, s78, 1040
    s_add_u32 m0, s79, s59
    s_lshl_b32 s78, s78, 10
    s_add_u32 s78, s78, s77
    buffer_load_dwordx4 v101, s[48:51], s78 offen lds
    s_add_u32 s78, s76, 1
    s_and_b32 s78, s78, 31
    s_mul_i32 s79, s78, 1040
    s_add_u32 m0, s79, s59
    s_lshl_b32 s78, s78, 10
    s_add_u32 s78, s78, s77
    buffer_load_dwordx4 v101, s[48:51], s78 offen lds
    s_add_u32 s78, s76, 2
    s_and_b32 s78, s78, 31
    s_mul_i32 s79, s78, 1040
    s_add_u32 m0, s79, s59
    s_lshl_b32 s78, s78, 10
    s_add_u32 s78, s78, s77
    buffer_load_dwordx4 v101, s[48:51], s78 offen lds
    s_add_u32 s78, s76, 3
    s_and_b32 s78, s78, 31
    s_mul_i32 s79, s78, 1040
    s_add_u32 m0, s79, s59
    s_lshl_b32 s78, s78, 10
    s_add_u32 s78, s78, s77
    buffer_load_dwordx4 v101, s[48:51], s78 offen lds
    s_add_u32 s78, s76, 4
    s_and_b32 s78, s78, 31
    s_mul_i32 s79, s78, 1040
    s_add_u32 m0, s79, s59
    s_lshl_b32 s78, s78, 10
    s_add_u32 s78, s78, s77
    buffer_load_dwordx4 v101, s[48:51], s78 offen lds
    s_add_u32 s78, s76, 5
    s_and_b32 s78, s78, 31
    s_mul_i32 s79, s78, 1040
    s_add_u32 m0, s79, s59
    s_lshl_b32 s78, s78, 10
    s_add_u32 s78, s78, s77
    buffer_load_dwordx4 v101, s[48:51], s78 offen lds
    s_add_u32 s78, s76, 6
    s_and_b32 s78, s78, 31
    s_mul_i32 s79, s78, 1040
    s_add_u32 m0, s79, s59
    s_lshl_b32 s78, s78, 10
    s_add_u32 s78, s78, s77
    buffer_load_dwordx4 v101, s[48:51], s78 offen lds
    s_add_u32 s78, s76, 7
    s_and_b32 s78, s78, 31
    s_mul_i32 s79, s78, 1040
    s_add_u32 m0, s79, s59
    s_lshl_b32 s78, s78, 10
    s_add_u32 s78, s78, s77
    buffer_load_dwordx4 v101, s[48:51], s78 offen lds
    v_mul_u32_u24 v103, 1040, v98
    v_lshl_add_u32 v1, v99, 8, v103
    v_lshl_add_u32 v2, v96, 8, v103
    v_lshl_add_u32 v2, v99, 4, v2
    v_mul_u32_u24 v103, 80, v98
    v_add_u32 v103, 66560, v103
    v_mul_u32_u24 v3, 5120, v99
    v_add_u32 v3, v3, v103
    v_mul_u32_u24 v4, 5120, v96
    v_add_u32 v4, v4, v103
    v_lshl_add_u32 v4, v99, 4, v4
    v_lshlrev_b32 v5, 5, v99
    v_lshl_add_u32 v5, v96, 9, v5
    v_add_u32 v5, 133120, v5
    s_mov_b32 s23, 393216
    v_mul_lo_u32 v6, v96, s23
    v_add_u32 v6, v6, v101
    v_lshrrev_b32 v104, 2, v98
    v_and_b32 v105, 3, v98
    v_lshl_add_u32 v100, v104, 3, v105
    v_lshl_add_u32 v7, v96, 5, v100
    v_lshlrev_b32 v7, 10, v7
    v_lshl_add_u32 v7, v99, 8, v7
    v_lshl_add_u32 v12, v96, 7, v100
    v_lshlrev_b32 v12, 8, v12
    v_lshl_add_u32 v12, v99, 6, v12
    v_lshlrev_b32 v13, 4, v0
    v_add_u32 v13, 1572864, v13
    v_lshlrev_b32 v14, 2, v0
    v_add_u32 v14, 145408, v14
    ds_write_b32 v14, v15
    v_add_u32 v0, 145408, v101
    s_lshl_b32 s58, s20, 8
    s_add_u32 s58, s58, 145408
    v_mul_u32_u24 v103, 1040, v100
    v_lshl_add_u32 v103, v99, 8, v103
    v_add_u32 v16, s59, v103
    v_mul_u32_u24 v109, 2080, v104
    v_lshl_add_u32 v109, v105, 8, v109
    v_lshl_add_u32 v109, v99, 6, v109
    v_add_u32 v109, 133120, v109
    s_mov_b32 s21, 32768
    s_mov_b32 s56, 0
    s_mov_b32 s22, 0
    s_mov_b32 s81, 0xffff0000
    s_waitcnt vmcnt(14)
    buffer_load_dword v102, v15, s[52:55], 0 offen sc0 sc1
    ds_read_b128 v[48:51], v109 offset:0
    ds_read_b128 v[52:55], v109 offset:1040
    ds_read_b128 v[56:59], v109 offset:16
    ds_read_b128 v[60:63], v109 offset:1056
    ds_read_b128 v[64:67], v109 offset:32
    ds_read_b128 v[68:71], v109 offset:1072
    ds_read_b128 v[72:75], v109 offset:48
    ds_read_b128 v[76:79], v109 offset:1088
    s_waitcnt lgkmcnt(7)
    buffer_store_dwordx4 v[48:51], v101, s[8:11], s70 offen offset:0 sc1
    s_waitcnt lgkmcnt(6)
    buffer_store_dwordx4 v[52:55], v101, s[8:11], s70 offen offset:1024 sc1
    s_waitcnt lgkmcnt(5)
    buffer_store_dwordx4 v[56:59], v101, s[8:11], s70 offen offset:2048 sc1
    s_waitcnt lgkmcnt(4)
    buffer_store_dwordx4 v[60:63], v101, s[8:11], s70 offen offset:3072 sc1
    s_waitcnt lgkmcnt(3)
    buffer_store_dwordx4 v[64:67], v101, s[8:11], s71 offen offset:0 sc1
    s_waitcnt lgkmcnt(2)
    buffer_store_dwordx4 v[68:71], v101, s[8:11], s71 offen offset:1024 sc1
    s_waitcnt lgkmcnt(1)
    buffer_store_dwordx4 v[72:75], v101, s[8:11], s71 offen offset:2048 sc1
    s_waitcnt lgkmcnt(0)
    buffer_store_dwordx4 v[76:79], v101, s[8:11], s71 offen offset:3072 sc1
    s_waitcnt vmcnt(0)
    s_mov_b32 s61, 0
    s_branch L_nchk
L_npoll:
    buffer_load_dword v102, v15, s[52:55], 0 offen sc0 sc1
    s_waitcnt vmcnt(0)
L_nchk:
    v_readfirstlane_b32 s80, v102
    s_add_u32 s61, s61, 1
    s_nop 2
    s_cmp_lg_u32 s80, 0
    s_cbranch_scc1 L_ngot
    s_cmp_lt_u32 s61, 16
    s_cbranch_scc1 L_npoll
    s_mov_b32 s80, -2
    s_branch L_nshare
L_ngot:
    s_lshl_b32 s61, s2, 4
    s_add_u32 s61, s61, 1572864
    s_mov_b64 exec, 1
    buffer_store_dword v102, v15, s[8:11], s61 offen sc0 sc1
    s_mov_b64 exec, -1
    s_branch L_nshare2
L_nshare:
    buffer_load_dword v105, v15, s[52:55], 0 offen
L_nshare2:
    v_mov_b32 v104, s80
    v_mov_b32 v107, 146432
    ds_write_b32 v107, v104
    v_lshlrev_b32 v103, 1, v101
    v_add_u32 v103, 133120, v103
    v_lshlrev_b32 v160, 16, v128
    v_and_b32 v161, 0xffff0000, v128
    v_lshlrev_b32 v162, 16, v129
    v_and_b32 v163, 0xffff0000, v129
    v_lshlrev_b32 v164, 16, v130
    v_and_b32 v165, 0xffff0000, v130
    v_lshlrev_b32 v166, 16, v131
    v_and_b32 v167, 0xffff0000, v131
    ds_write_b128 v103, v[160:163] offset:0
    ds_write_b128 v103, v[164:167] offset:16
    v_lshlrev_b32 v168, 16, v132
    v_and_b32 v169, 0xffff0000, v132
    v_lshlrev_b32 v170, 16, v133
    v_and_b32 v171, 0xffff0000, v133
    v_lshlrev_b32 v172, 16, v134
    v_and_b32 v173, 0xffff0000, v134
    v_lshlrev_b32 v174, 16, v135
    v_and_b32 v175, 0xffff0000, v135
    ds_write_b128 v103, v[168:171] offset:2048
    ds_write_b128 v103, v[172:175] offset:2064
    v_lshlrev_b32 v176, 16, v136
    v_and_b32 v177, 0xffff0000, v136
    v_lshlrev_b32 v178, 16, v137
    v_and_b32 v179, 0xffff0000, v137
    v_lshlrev_b32 v180, 16, v138
    v_and_b32 v181, 0xffff0000, v138
    v_lshlrev_b32 v182, 16, v139
    v_and_b32 v183, 0xffff0000, v139
    ds_write_b128 v103, v[176:179] offset:4096
    ds_write_b128 v103, v[180:183] offset:4112
    v_lshlrev_b32 v184, 16, v140
    v_and_b32 v185, 0xffff0000, v140
    v_lshlrev_b32 v186, 16, v141
    v_and_b32 v187, 0xffff0000, v141
    v_lshlrev_b32 v188, 16, v142
    v_and_b32 v189, 0xffff0000, v142
    v_lshlrev_b32 v190, 16, v143
    v_and_b32 v191, 0xffff0000, v143
    ds_write_b128 v103, v[184:187] offset:6144
    ds_write_b128 v103, v[188:191] offset:6160
    v_lshlrev_b32 v192, 16, v144
    v_and_b32 v193, 0xffff0000, v144
    v_lshlrev_b32 v194, 16, v145
    v_and_b32 v195, 0xffff0000, v145
    v_lshlrev_b32 v196, 16, v146
    v_and_b32 v197, 0xffff0000, v146
    v_lshlrev_b32 v198, 16, v147
    v_and_b32 v199, 0xffff0000, v147
    ds_write_b128 v103, v[192:195] offset:8192
    ds_write_b128 v103, v[196:199] offset:8208
    v_lshlrev_b32 v200, 16, v148
    v_and_b32 v201, 0xffff0000, v148
    v_lshlrev_b32 v202, 16, v149
    v_and_b32 v203, 0xffff0000, v149
    v_lshlrev_b32 v204, 16, v150
    v_and_b32 v205, 0xffff0000, v150
    v_lshlrev_b32 v206, 16, v151
    v_and_b32 v207, 0xffff0000, v151
    ds_write_b128 v103, v[200:203] offset:10240
    ds_write_b128 v103, v[204:207] offset:10256
    s_setprio 0
    s_waitcnt lgkmcnt(0)
    s_barrier
    ds_read_b128 a[0:3], v16 offset:0
    ds_read_b128 a[4:7], v16 offset:4160
    ds_read_b128 a[8:11], v16 offset:16
    ds_read_b128 a[12:15], v16 offset:4176
    ds_read_b128 a[16:19], v16 offset:32
    ds_read_b128 a[20:23], v16 offset:4192
    ds_read_b128 a[24:27], v16 offset:48
    ds_read_b128 a[28:31], v16 offset:4208
    s_waitcnt lgkmcnt(6)
    ds_read_b128 a[32:35], v16 offset:64
    ds_read_b128 a[36:39], v16 offset:4224
    ds_read_b128 a[40:43], v16 offset:80
    ds_read_b128 a[44:47], v16 offset:4240
    ds_read_b128 a[48:51], v16 offset:96
    ds_read_b128 a[52:55], v16 offset:4256
    ds_read_b128 a[56:59], v16 offset:112
    ds_read_b128 a[60:63], v16 offset:4272
    s_waitcnt lgkmcnt(6)
    ds_read_b128 a[64:67], v16 offset:128
    ds_read_b128 a[68:71], v16 offset:4288
    ds_read_b128 a[72:75], v16 offset:144
    ds_read_b128 a[76:79], v16 offset:4304
    ds_read_b128 a[80:83], v16 offset:160
    ds_read_b128 a[84:87], v16 offset:4320
    ds_read_b128 a[88:91], v16 offset:176
    ds_read_b128 a[92:95], v16 offset:4336
    s_waitcnt lgkmcnt(6)
    ds_read_b128 a[96:99], v16 offset:192
    ds_read_b128 a[100:103], v16 offset:4352
    ds_read_b128 a[104:107], v16 offset:208
    ds_read_b128 a[108:111], v16 offset:4368
    ds_read_b128 a[112:115], v16 offset:224
    ds_read_b128 a[116:119], v16 offset:4384
    ds_read_b128 a[120:123], v16 offset:240
    ds_read_b128 a[124:127], v16 offset:4400
    s_waitcnt lgkmcnt(0)
    s_barrier
    s_branch L_join
L_w012:
    s_lshl_b32 s38, s2, 16
    s_add_u32 s78, s76, 0
    s_and_b32 s78, s78, 31
    s_mul_i32 s79, s78, 1040
    s_add_u32 m0, s79, s59
    s_lshl_b32 s78, s78, 10
    s_add_u32 s78, s78, s77
    buffer_load_dwordx4 v101, s[48:51], s78 offen lds
    s_add_u32 s78, s76, 1
    s_and_b32 s78, s78, 31
    s_mul_i32 s79, s78, 1040
    s_add_u32 m0, s79, s59
    s_lshl_b32 s78, s78, 10
    s_add_u32 s78, s78, s77
    buffer_load_dwordx4 v101, s[48:51], s78 offen lds
    s_add_u32 s78, s76, 2
    s_and_b32 s78, s78, 31
    s_mul_i32 s79, s78, 1040
    s_add_u32 m0, s79, s59
    s_lshl_b32 s78, s78, 10
    s_add_u32 s78, s78, s77
    buffer_load_dwordx4 v101, s[48:51], s78 offen lds
    s_add_u32 s78, s76, 3
    s_and_b32 s78, s78, 31
    s_mul_i32 s79, s78, 1040
    s_add_u32 m0, s79, s59
    s_lshl_b32 s78, s78, 10
    s_add_u32 s78, s78, s77
    buffer_load_dwordx4 v101, s[48:51], s78 offen lds
    s_add_u32 s78, s76, 4
    s_and_b32 s78, s78, 31
    s_mul_i32 s79, s78, 1040
    s_add_u32 m0, s79, s59
    s_lshl_b32 s78, s78, 10
    s_add_u32 s78, s78, s77
    buffer_load_dwordx4 v101, s[48:51], s78 offen lds
    s_add_u32 s78, s76, 5
    s_and_b32 s78, s78, 31
    s_mul_i32 s79, s78, 1040
    s_add_u32 m0, s79, s59
    s_lshl_b32 s78, s78, 10
    s_add_u32 s78, s78, s77
    buffer_load_dwordx4 v101, s[48:51], s78 offen lds
    s_add_u32 s78, s76, 6
    s_and_b32 s78, s78, 31
    s_mul_i32 s79, s78, 1040
    s_add_u32 m0, s79, s59
    s_lshl_b32 s78, s78, 10
    s_add_u32 s78, s78, s77
    buffer_load_dwordx4 v101, s[48:51], s78 offen lds
    s_add_u32 s78, s76, 7
    s_and_b32 s78, s78, 31
    s_mul_i32 s79, s78, 1040
    s_add_u32 m0, s79, s59
    s_lshl_b32 s78, s78, 10
    s_add_u32 s78, s78, s77
    buffer_load_dwordx4 v101, s[48:51], s78 offen lds
    s_add_u32 s39, s20, 0
    s_min_u32 s39, s39, 63
    s_lshl_b32 s39, s39, 10
    s_add_u32 s39, s38, s39
    buffer_load_dwordx4 v[128:131], v101, s[4:7], s39 offen offset:0 nt
    s_add_u32 s78, s76, 8
    s_and_b32 s78, s78, 31
    s_mul_i32 s79, s78, 1040
    s_add_u32 m0, s79, s59
    s_lshl_b32 s78, s78, 10
    s_add_u32 s78, s78, s77
    buffer_load_dwordx4 v101, s[48:51], s78 offen lds
    s_add_u32 s78, s76, 9
    s_and_b32 s78, s78, 31
    s_mul_i32 s79, s78, 1040
    s_add_u32 m0, s79, s59
    s_lshl_b32 s78, s78, 10
    s_add_u32 s78, s78, s77
    buffer_load_dwordx4 v101, s[48:51], s78 offen lds
    s_add_u32 s78, s76, 10
    s_and_b32 s78, s78, 31
    s_mul_i32 s79, s78, 1040
    s_add_u32 m0, s79, s59
    s_lshl_b32 s78, s78, 10
    s_add_u32 s78, s78, s77
    buffer_load_dwordx4 v101, s[48:51], s78 offen lds
    s_add_u32 s78, s76, 11
    s_and_b32 s78, s78, 31
    s_mul_i32 s79, s78, 1040
    s_add_u32 m0, s79, s59
    s_lshl_b32 s78, s78, 10
    s_add_u32 s78, s78, s77
    buffer_load_dwordx4 v101, s[48:51], s78 offen lds
    s_add_u32 s78, s76, 12
    s_and_b32 s78, s78, 31
    s_mul_i32 s79, s78, 1040
    s_add_u32 m0, s79, s59
    s_lshl_b32 s78, s78, 10
    s_add_u32 s78, s78, s77
    buffer_load_dwordx4 v101, s[48:51], s78 offen lds
    s_add_u32 s78, s76, 13
    s_and_b32 s78, s78, 31
    s_mul_i32 s79, s78, 1040
    s_add_u32 m0, s79, s59
    s_lshl_b32 s78, s78, 10
    s_add_u32 s78, s78, s77
    buffer_load_dwordx4 v101, s[48:51], s78 offen lds
    s_add_u32 s78, s76, 14
    s_and_b32 s78, s78, 31
    s_mul_i32 s79, s78, 1040
    s_add_u32 m0, s79, s59
    s_lshl_b32 s78, s78, 10
    s_add_u32 s78, s78, s77
    buffer_load_dwordx4 v101, s[48:51], s78 offen lds
    s_add_u32 s78, s76, 15
    s_and_b32 s78, s78, 31
    s_mul_i32 s79, s78, 1040
    s_add_u32 m0, s79, s59
    s_lshl_b32 s78, s78, 10
    s_add_u32 s78, s78, s77
    buffer_load_dwordx4 v101, s[48:51], s78 offen lds
    s_add_u32 s39, s20, 3
    s_min_u32 s39, s39, 63
    s_lshl_b32 s39, s39, 10
    s_add_u32 s39, s38, s39
    buffer_load_dwordx4 v[132:135], v101, s[4:7], s39 offen offset:0 nt
    s_add_u32 s78, s76, 16
    s_and_b32 s78, s78, 31
    s_mul_i32 s79, s78, 1040
    s_add_u32 m0, s79, s59
    s_lshl_b32 s78, s78, 10
    s_add_u32 s78, s78, s77
    buffer_load_dwordx4 v101, s[48:51], s78 offen lds
    s_add_u32 s78, s76, 17
    s_and_b32 s78, s78, 31
    s_mul_i32 s79, s78, 1040
    s_add_u32 m0, s79, s59
    s_lshl_b32 s78, s78, 10
    s_add_u32 s78, s78, s77
    buffer_load_dwordx4 v101, s[48:51], s78 offen lds
    s_add_u32 s78, s76, 18
    s_and_b32 s78, s78, 31
    s_mul_i32 s79, s78, 1040
    s_add_u32 m0, s79, s59
    s_lshl_b32 s78, s78, 10
    s_add_u32 s78, s78, s77
    buffer_load_dwordx4 v101, s[48:51], s78 offen lds
    s_add_u32 s78, s76, 19
    s_and_b32 s78, s78, 31
    s_mul_i32 s79, s78, 1040
    s_add_u32 m0, s79, s59
    s_lshl_b32 s78, s78, 10
    s_add_u32 s78, s78, s77
    buffer_load_dwordx4 v101, s[48:51], s78 offen lds
    s_add_u32 s78, s76, 20
    s_and_b32 s78, s78, 31
    s_mul_i32 s79, s78, 1040
    s_add_u32 m0, s79, s59
    s_lshl_b32 s78, s78, 10
    s_add_u32 s78, s78, s77
    buffer_load_dwordx4 v101, s[48:51], s78 offen lds
    s_add_u32 s78, s76, 21
    s_and_b32 s78, s78, 31
    s_mul_i32 s79, s78, 1040
    s_add_u32 m0, s79, s59
    s_lshl_b32 s78, s78, 10
    s_add_u32 s78, s78, s77
    buffer_load_dwordx4 v101, s[48:51], s78 offen lds
    s_add_u32 s78, s76, 22
    s_and_b32 s78, s78, 31
    s_mul_i32 s79, s78, 1040
    s_add_u32 m0, s79, s59
    s_lshl_b32 s78, s78, 10
    s_add_u32 s78, s78, s77
    buffer_load_dwordx4 v101, s[48:51], s78 offen lds
    s_add_u32 s78, s76, 23
    s_and_b32 s78, s78, 31
    s_mul_i32 s79, s78, 1040
    s_add_u32 m0, s79, s59
    s_lshl_b32 s78, s78, 10
    s_add_u32 s78, s78, s77
    buffer_load_dwordx4 v101, s[48:51], s78 offen lds
    s_add_u32 s39, s20, 6
    s_min_u32 s39, s39, 63
    s_lshl_b32 s39, s39, 10
    s_add_u32 s39, s38, s39
    buffer_load_dwordx4 v[136:139], v101, s[4:7], s39 offen offset:0 nt
    s_add_u32 s78, s76, 24
    s_and_b32 s78, s78, 31
    s_mul_i32 s79, s78, 1040
    s_add_u32 m0, s79, s59
    s_lshl_b32 s78, s78, 10
    s_add_u32 s78, s78, s77
    buffer_load_dwordx4 v101, s[48:51], s78 offen lds
    s_add_u32 s78, s76, 25
    s_and_b32 s78, s78, 31
    s_mul_i32 s79, s78, 1040
    s_add_u32 m0, s79, s59
    s_lshl_b32 s78, s78, 10
    s_add_u32 s78, s78, s77
    buffer_load_dwordx4 v101, s[48:51], s78 offen lds
    s_add_u32 s78, s76, 26
    s_and_b32 s78, s78, 31
    s_mul_i32 s79, s78, 1040
    s_add_u32 m0, s79, s59
    s_lshl_b32 s78, s78, 10
    s_add_u32 s78, s78, s77
    buffer_load_dwordx4 v101, s[48:51], s78 offen lds
    s_add_u32 s78, s76, 27
    s_and_b32 s78, s78, 31
    s_mul_i32 s79, s78, 1040
    s_add_u32 m0, s79, s59
    s_lshl_b32 s78, s78, 10
    s_add_u32 s78, s78, s77
    buffer_load_dwordx4 v101, s[48:51], s78 offen lds
    s_add_u32 s78, s76, 28
    s_and_b32 s78, s78, 31
    s_mul_i32 s79, s78, 1040
    s_add_u32 m0, s79, s59
    s_lshl_b32 s78, s78, 10
    s_add_u32 s78, s78, s77
    buffer_load_dwordx4 v101, s[48:51], s78 offen lds
    s_add_u32 s78, s76, 29
    s_and_b32 s78, s78, 31
    s_mul_i32 s79, s78, 1040
    s_add_u32 m0, s79, s59
    s_lshl_b32 s78, s78, 10
    s_add_u32 s78, s78, s77
    buffer_load_dwordx4 v101, s[48:51], s78 offen lds
    s_add_u32 s78, s76, 30
    s_and_b32 s78, s78, 31
    s_mul_i32 s79, s78, 1040
    s_add_u32 m0, s79, s59
    s_lshl_b32 s78, s78, 10
    s_add_u32 s78, s78, s77
    buffer_load_dwordx4 v101, s[48:51], s78 offen lds
    s_add_u32 s78, s76, 31
    s_and_b32 s78, s78, 31
    s_mul_i32 s79, s78, 1040
    s_add_u32 m0, s79, s59
    s_lshl_b32 s78, s78, 10
    s_add_u32 s78, s78, s77
    buffer_load_dwordx4 v101, s[48:51], s78 offen lds
    s_add_u32 s39, s20, 9
    s_min_u32 s39, s39, 63
    s_lshl_b32 s39, s39, 10
    s_add_u32 s39, s38, s39
    buffer_load_dwordx4 v[140:143], v101, s[4:7], s39 offen offset:0 nt
    s_add_u32 s78, s20, 8
    s_add_u32 s78, s78, s76
    s_and_b32 s78, s78, 31
    s_mul_i32 s79, s78, 1040
    s_add_u32 m0, s79, 99840
    s_lshl_b32 s78, s78, 10
    s_add_u32 s78, s78, 98304
    buffer_load_dwordx4 v101, s[48:51], s78 offen lds
    s_add_u32 s78, s20, 11
    s_add_u32 s78, s78, s76
    s_and_b32 s78, s78, 31
    s_mul_i32 s79, s78, 1040
    s_add_u32 m0, s79, 99840
    s_lshl_b32 s78, s78, 10
    s_add_u32 s78, s78, 98304
    buffer_load_dwordx4 v101, s[48:51], s78 offen lds
    s_add_u32 s78, s20, 14
    s_add_u32 s78, s78, s76
    s_and_b32 s78, s78, 31
    s_mul_i32 s79, s78, 1040
    s_add_u32 m0, s79, 99840
    s_lshl_b32 s78, s78, 10
    s_add_u32 s78, s78, 98304
    buffer_load_dwordx4 v101, s[48:51], s78 offen lds
    s_add_u32 s78, s20, 17
    s_add_u32 s78, s78, s76
    s_and_b32 s78, s78, 31
    s_mul_i32 s79, s78, 1040
    s_add_u32 m0, s79, 99840
    s_lshl_b32 s78, s78, 10
    s_add_u32 s78, s78, 98304
    buffer_load_dwordx4 v101, s[48:51], s78 offen lds
    s_add_u32 s78, s20, 20
    s_add_u32 s78, s78, s76
    s_and_b32 s78, s78, 31
    s_mul_i32 s79, s78, 1040
    s_add_u32 m0, s79, 99840
    s_lshl_b32 s78, s78, 10
    s_add_u32 s78, s78, 98304
    buffer_load_dwordx4 v101, s[48:51], s78 offen lds
    s_add_u32 s78, s20, 23
    s_add_u32 s78, s78, s76
    s_and_b32 s78, s78, 31
    s_mul_i32 s79, s78, 1040
    s_add_u32 m0, s79, 99840
    s_lshl_b32 s78, s78, 10
    s_add_u32 s78, s78, 98304
    buffer_load_dwordx4 v101, s[48:51], s78 offen lds
    s_add_u32 s78, s20, 26
    s_add_u32 s78, s78, s76
    s_and_b32 s78, s78, 31
    s_mul_i32 s79, s78, 1040
    s_add_u32 m0, s79, 99840
    s_lshl_b32 s78, s78, 10
    s_add_u32 s78, s78, 98304
    buffer_load_dwordx4 v101, s[48:51], s78 offen lds
    s_add_u32 s78, s20, 29
    s_add_u32 s78, s78, s76
    s_and_b32 s78, s78, 31
    s_mul_i32 s79, s78, 1040
    s_add_u32 m0, s79, 99840
    s_lshl_b32 s78, s78, 10
    s_add_u32 s78, s78, 98304
    buffer_load_dwordx4 v101, s[48:51], s78 offen lds
    s_add_u32 s39, s20, 12
    s_min_u32 s39, s39, 63
    s_lshl_b32 s39, s39, 10
    s_add_u32 s39, s38, s39
    buffer_load_dwordx4 v[144:147], v101, s[4:7], s39 offen offset:0 nt
    s_add_u32 s39, s20, 15
    s_min_u32 s39, s39, 63
    s_lshl_b32 s39, s39, 10
    s_add_u32 s39, s38, s39
    buffer_load_dwordx4 v[148:151], v101, s[4:7], s39 offen offset:0 nt
    s_add_u32 s39, s20, 18
    s_min_u32 s39, s39, 63
    s_lshl_b32 s39, s39, 10
    s_add_u32 s39, s38, s39
    buffer_load_dwordx4 v[152:155], v101, s[4:7], s39 offen offset:0 nt
    s_add_u32 s39, s20, 21
    s_min_u32 s39, s39, 63
    s_lshl_b32 s39, s39, 10
    s_add_u32 s39, s38, s39
    buffer_load_dwordx4 v[156:159], v101, s[4:7], s39 offen offset:0 nt
    s_add_u32 s39, s20, 24
    s_min_u32 s39, s39, 63
    s_lshl_b32 s39, s39, 10
    s_add_u32 s39, s38, s39
    buffer_load_dwordx4 v[160:163], v101, s[4:7], s39 offen offset:0 nt
    s_add_u32 s39, s20, 27
    s_min_u32 s39, s39, 63
    s_lshl_b32 s39, s39, 10
    s_add_u32 s39, s38, s39
    buffer_load_dwordx4 v[164:167], v101, s[4:7], s39 offen offset:0 nt
    s_add_u32 s39, s20, 30
    s_min_u32 s39, s39, 63
    s_lshl_b32 s39, s39, 10
    s_add_u32 s39, s38, s39
    buffer_load_dwordx4 v[168:171], v101, s[4:7], s39 offen offset:0 nt
    s_add_u32 s39, s20, 33
    s_min_u32 s39, s39, 63
    s_lshl_b32 s39, s39, 10
    s_add_u32 s39, s38, s39
    buffer_load_dwordx4 v[172:175], v101, s[4:7], s39 offen offset:0 nt
    s_mov_b32 s44, s26
    s_and_b32 s45, s27, 0xffff
    s_mov_b32 s46, 786432
    s_mov_b32 s47, 0x00020000
    s_mov_b32 s16, s30
    s_and_b32 s17, s31, 0xffff
    s_mov_b32 s18, 6144
    s_mov_b32 s19, 0x00020000
    s_mov_b32 s12, s32
    s_and_b32 s13, s33, 0xffff
    s_mov_b32 s14, 16777216
    s_mov_b32 s15, 0x00020000
    s_mov_b32 s52, s34
    s_and_b32 s53, s35, 0xffff
    s_mov_b32 s54, 256
    s_mov_b32 s55, 0x00020000
    s_mov_b32 s8, s36
    s_and_b32 s9, s37, 0xffff
    s_mov_b32 s10, 1576960
    s_mov_b32 s11, 0x00020000
    v_mul_u32_u24 v103, 1040, v98
    v_lshl_add_u32 v1, v99, 8, v103
    v_lshl_add_u32 v2, v96, 8, v103
    v_lshl_add_u32 v2, v99, 4, v2
    v_mul_u32_u24 v103, 80, v98
    v_add_u32 v103, 66560, v103
    v_mul_u32_u24 v3, 5120, v99
    v_add_u32 v3, v3, v103
    v_mul_u32_u24 v4, 5120, v96
    v_add_u32 v4, v4, v103
    v_lshl_add_u32 v4, v99, 4, v4
    v_lshlrev_b32 v5, 5, v99
    v_lshl_add_u32 v5, v96, 9, v5
    v_add_u32 v5, 133120, v5
    s_mov_b32 s23, 393216
    v_mul_lo_u32 v6, v96, s23
    v_add_u32 v6, v6, v101
    v_lshrrev_b32 v104, 2, v98
    v_and_b32 v105, 3, v98
    v_lshl_add_u32 v100, v104, 3, v105
    v_lshl_add_u32 v7, v96, 5, v100
    v_lshlrev_b32 v7, 10, v7
    v_lshl_add_u32 v7, v99, 8, v7
    v_lshl_add_u32 v12, v96, 7, v100
    v_lshlrev_b32 v12, 8, v12
    v_lshl_add_u32 v12, v99, 6, v12
    v_lshlrev_b32 v13, 4, v0
    v_add_u32 v13, 1572864, v13
    v_lshlrev_b32 v14, 2, v0
    v_add_u32 v14, 145408, v14
    ds_write_b32 v14, v15
    v_add_u32 v0, 145408, v101
    s_lshl_b32 s58, s20, 8
    s_add_u32 s58, s58, 145408
    v_mul_u32_u24 v103, 1040, v100
    v_lshl_add_u32 v103, v99, 8, v103
    v_add_u32 v16, s59, v103
    v_mul_u32_u24 v109, 2080, v104
    v_lshl_add_u32 v109, v105, 8, v109
    v_lshl_add_u32 v109, v99, 6, v109
    v_add_u32 v109, 133120, v109
    s_mov_b32 s21, 32768
    s_mov_b32 s56, 0
    s_mov_b32 s22, 0
    s_mov_b32 s81, 0xffff0000
    s_waitcnt vmcnt(8) lgkmcnt(0)
    s_barrier
    ds_read_b128 a[0:3], v16 offset:0
    ds_read_b128 a[4:7], v16 offset:4160
    ds_read_b128 a[8:11], v16 offset:16
    ds_read_b128 a[12:15], v16 offset:4176
    ds_read_b128 a[16:19], v16 offset:32
    ds_read_b128 a[20:23], v16 offset:4192
    ds_read_b128 a[24:27], v16 offset:48
    ds_read_b128 a[28:31], v16 offset:4208
    s_waitcnt lgkmcnt(6)
    ds_read_b128 a[32:35], v16 offset:64
    ds_read_b128 a[36:39], v16 offset:4224
    ds_read_b128 a[40:43], v16 offset:80
    ds_read_b128 a[44:47], v16 offset:4240
    ds_read_b128 a[48:51], v16 offset:96
    ds_read_b128 a[52:55], v16 offset:4256
    ds_read_b128 a[56:59], v16 offset:112
    ds_read_b128 a[60:63], v16 offset:4272
    s_waitcnt lgkmcnt(6)
    ds_read_b128 a[64:67], v16 offset:128
    ds_read_b128 a[68:71], v16 offset:4288
    ds_read_b128 a[72:75], v16 offset:144
    ds_read_b128 a[76:79], v16 offset:4304
    ds_read_b128 a[80:83], v16 offset:160
    ds_read_b128 a[84:87], v16 offset:4320
    ds_read_b128 a[88:91], v16 offset:176
    ds_read_b128 a[92:95], v16 offset:4336
    s_waitcnt lgkmcnt(6)
    ds_read_b128 a[96:99], v16 offset:192
    ds_read_b128 a[100:103], v16 offset:4352
    ds_read_b128 a[104:107], v16 offset:208
    ds_read_b128 a[108:111], v16 offset:4368
    ds_read_b128 a[112:115], v16 offset:224
    ds_read_b128 a[116:119], v16 offset:4384
    ds_read_b128 a[120:123], v16 offset:240
    ds_read_b128 a[124:127], v16 offset:4400
    s_waitcnt lgkmcnt(0)
    s_add_u32 s39, s20, 36
    s_min_u32 s39, s39, 63
    s_lshl_b32 s39, s39, 10
    s_add_u32 s39, s38, s39
    buffer_load_dwordx4 v[176:179], v101, s[4:7], s39 offen offset:0 nt
    s_add_u32 s39, s20, 39
    s_min_u32 s39, s39, 63
    s_lshl_b32 s39, s39, 10
    s_add_u32 s39, s38, s39
    buffer_load_dwordx4 v[180:183], v101, s[4:7], s39 offen offset:0 nt
    s_add_u32 s39, s20, 42
    s_min_u32 s39, s39, 63
    s_lshl_b32 s39, s39, 10
    s_add_u32 s39, s38, s39
    buffer_load_dwordx4 v[184:187], v101, s[4:7], s39 offen offset:0 nt
    s_add_u32 s39, s20, 45
    s_min_u32 s39, s39, 63
    s_lshl_b32 s39, s39, 10
    s_add_u32 s39, s38, s39
    buffer_load_dwordx4 v[188:191], v101, s[4:7], s39 offen offset:0 nt
    s_add_u32 s39, s20, 48
    s_min_u32 s39, s39, 63
    s_lshl_b32 s39, s39, 10
    s_add_u32 s39, s38, s39
    buffer_load_dwordx4 v[192:195], v101, s[4:7], s39 offen offset:0 nt
    s_add_u32 s39, s20, 51
    s_min_u32 s39, s39, 63
    s_lshl_b32 s39, s39, 10
    s_add_u32 s39, s38, s39
    buffer_load_dwordx4 v[196:199], v101, s[4:7], s39 offen offset:0 nt
    s_add_u32 s39, s20, 54
    s_min_u32 s39, s39, 63
    s_lshl_b32 s39, s39, 10
    s_add_u32 s39, s38, s39
    buffer_load_dwordx4 v[200:203], v101, s[4:7], s39 offen offset:0 nt
    s_add_u32 s39, s20, 57
    s_min_u32 s39, s39, 63
    s_lshl_b32 s39, s39, 10
    s_add_u32 s39, s38, s39
    buffer_load_dwordx4 v[204:207], v101, s[4:7], s39 offen offset:0 nt
    s_add_u32 s39, s20, 60
    s_min_u32 s39, s39, 63
    s_lshl_b32 s39, s39, 10
    s_add_u32 s39, s38, s39
    buffer_load_dwordx4 v[208:211], v101, s[4:7], s39 offen offset:0 nt
    s_add_u32 s39, s20, 63
    s_min_u32 s39, s39, 63
    s_lshl_b32 s39, s39, 10
    s_add_u32 s39, s38, s39
    buffer_load_dwordx4 v[212:215], v101, s[4:7], s39 offen offset:0 nt
    s_barrier
    s_add_u32 s24, s20, 0
    s_min_u32 s24, s24, 63
    s_mul_i32 s24, s24, 1040
    v_add_u32 v102, s24, v101
    ds_write_b128 v102, v[128:131] offset:0
    s_add_u32 s24, s20, 3
    s_min_u32 s24, s24, 63
    s_mul_i32 s24, s24, 1040
    v_add_u32 v103, s24, v101
    ds_write_b128 v103, v[132:135] offset:0
    s_add_u32 s24, s20, 6
    s_min_u32 s24, s24, 63
    s_mul_i32 s24, s24, 1040
    v_add_u32 v102, s24, v101
    ds_write_b128 v102, v[136:139] offset:0
    s_add_u32 s24, s20, 9
    s_min_u32 s24, s24, 63
    s_mul_i32 s24, s24, 1040
    v_add_u32 v103, s24, v101
    ds_write_b128 v103, v[140:143] offset:0
    s_add_u32 s24, s20, 12
    s_min_u32 s24, s24, 63
    s_mul_i32 s24, s24, 1040
    v_add_u32 v102, s24, v101
    s_waitcnt vmcnt(17)
    ds_write_b128 v102, v[144:147] offset:0
    s_add_u32 s24, s20, 15
    s_min_u32 s24, s24, 63
    s_mul_i32 s24, s24, 1040
    v_add_u32 v103, s24, v101
    s_waitcnt vmcnt(16)
    ds_write_b128 v103, v[148:151] offset:0
    s_add_u32 s24, s20, 18
    s_min_u32 s24, s24, 63
    s_mul_i32 s24, s24, 1040
    v_add_u32 v102, s24, v101
    s_waitcnt vmcnt(15)
    ds_write_b128 v102, v[152:155] offset:0
    s_add_u32 s24, s20, 21
    s_min_u32 s24, s24, 63
    s_mul_i32 s24, s24, 1040
    v_add_u32 v103, s24, v101
    s_waitcnt vmcnt(14)
    ds_write_b128 v103, v[156:159] offset:0
    s_waitcnt lgkmcnt(4)
    s_add_u32 s24, s20, 24
    s_min_u32 s24, s24, 63
    s_mul_i32 s24, s24, 1040
    v_add_u32 v102, s24, v101
    s_waitcnt vmcnt(13)
    ds_write_b128 v102, v[160:163] offset:0
    s_add_u32 s24, s20, 27
    s_min_u32 s24, s24, 63
    s_mul_i32 s24, s24, 1040
    v_add_u32 v103, s24, v101
    s_waitcnt vmcnt(12)
    ds_write_b128 v103, v[164:167] offset:0
    s_add_u32 s24, s20, 30
    s_min_u32 s24, s24, 63
    s_mul_i32 s24, s24, 1040
    v_add_u32 v102, s24, v101
    s_waitcnt vmcnt(11)
    ds_write_b128 v102, v[168:171] offset:0
    s_add_u32 s24, s20, 33
    s_min_u32 s24, s24, 63
    s_mul_i32 s24, s24, 1040
    v_add_u32 v103, s24, v101
    s_waitcnt vmcnt(10)
    ds_write_b128 v103, v[172:175] offset:0
    s_add_u32 s24, s20, 36
    s_min_u32 s24, s24, 63
    s_mul_i32 s24, s24, 1040
    v_add_u32 v102, s24, v101
    s_waitcnt vmcnt(9)
    ds_write_b128 v102, v[176:179] offset:0
    s_add_u32 s24, s20, 39
    s_min_u32 s24, s24, 63
    s_mul_i32 s24, s24, 1040
    v_add_u32 v103, s24, v101
    s_waitcnt vmcnt(8)
    ds_write_b128 v103, v[180:183] offset:0
    s_add_u32 s24, s20, 42
    s_min_u32 s24, s24, 63
    s_mul_i32 s24, s24, 1040
    v_add_u32 v102, s24, v101
    s_waitcnt vmcnt(7)
    ds_write_b128 v102, v[184:187] offset:0
    s_add_u32 s24, s20, 45
    s_min_u32 s24, s24, 63
    s_mul_i32 s24, s24, 1040
    v_add_u32 v103, s24, v101
    s_waitcnt vmcnt(6)
    ds_write_b128 v103, v[188:191] offset:0
    s_waitcnt lgkmcnt(4)
    s_add_u32 s24, s20, 48
    s_min_u32 s24, s24, 63
    s_mul_i32 s24, s24, 1040
    v_add_u32 v102, s24, v101
    s_waitcnt vmcnt(5)
    ds_write_b128 v102, v[192:195] offset:0
    s_add_u32 s24, s20, 51
    s_min_u32 s24, s24, 63
    s_mul_i32 s24, s24, 1040
    v_add_u32 v103, s24, v101
    s_waitcnt vmcnt(4)
    ds_write_b128 v103, v[196:199] offset:0
    s_add_u32 s24, s20, 54
    s_min_u32 s24, s24, 63
    s_mul_i32 s24, s24, 1040
    v_add_u32 v102, s24, v101
    s_waitcnt vmcnt(3)
    ds_write_b128 v102, v[200:203] offset:0
    s_add_u32 s24, s20, 57
    s_min_u32 s24, s24, 63
    s_mul_i32 s24, s24, 1040
    v_add_u32 v103, s24, v101
    s_waitcnt vmcnt(2)
    ds_write_b128 v103, v[204:207] offset:0
    s_add_u32 s24, s20, 60
    s_min_u32 s24, s24, 63
    s_mul_i32 s24, s24, 1040
    v_add_u32 v102, s24, v101
    s_waitcnt vmcnt(1)
    ds_write_b128 v102, v[208:211] offset:0
    s_add_u32 s24, s20, 63
    s_min_u32 s24, s24, 63
    s_mul_i32 s24, s24, 1040
    v_add_u32 v103, s24, v101
    s_waitcnt vmcnt(0)
    ds_write_b128 v103, v[212:215] offset:0
L_join:
    s_mov_b32 m0, s58
    s_nop 0
    buffer_load_dword v13, s[8:11], 0 offen sc0 sc1 lds
    s_waitcnt lgkmcnt(0)
    s_barrier
    v_mov_b32 v107, 146432
    ds_read_b32 v104, v107
    ds_read_b128 a[192:195], v1 offset:0
    ds_read_b128 a[196:199], v1 offset:16640
    ds_read_b128 a[200:203], v1 offset:16
    ds_read_b128 a[204:207], v1 offset:16656
    s_waitcnt lgkmcnt(4)
    v_readfirstlane_b32 s80, v104
L_Ntop:
    s_waitcnt lgkmcnt(3)
    v_mfma_f32_16x16x32_bf16 v[80:83], a[0:3], a[192:195], 0
    ds_read_b128 a[208:211], v1 offset:32
    ds_read_b128 v[48:51], v2 offset:0
    ds_read_b128 v[52:55], v2 offset:16640
    ds_read_b128 v[56:59], v2 offset:33280
    s_waitcnt lgkmcnt(6)
    v_mfma_f32_16x16x32_bf16 v[88:91], a[0:3], a[196:199], 0
    ds_read_b128 v[60:63], v2 offset:49920
    s_mov_b32 m0, s58
    s_nop 0
    buffer_load_dword v13, s[8:11], 0 offen sc0 sc1 lds
    v_mfma_f32_16x16x32_bf16 v[84:87], a[4:7], a[192:195], 0
    ds_read_b128 a[212:215], v1 offset:16672
    ds_read_b128 v[64:67], v2 offset:64
    v_mfma_f32_16x16x32_bf16 v[92:95], a[4:7], a[196:199], 0
    ds_read_b128 v[68:71], v2 offset:16704
    ds_read_b128 v[72:75], v2 offset:33344
    s_waitcnt lgkmcnt(10)
    v_mfma_f32_16x16x32_bf16 v[80:83], a[8:11], a[200:203], v[80:83]
    ds_read_b128 a[216:219], v1 offset:48
    ds_read_b128 v[76:79], v2 offset:49984
    s_waitcnt lgkmcnt(11)
    v_mfma_f32_16x16x32_bf16 v[88:91], a[8:11], a[204:207], v[88:91]
    s_waitcnt lgkmcnt(9)
    v_lshlrev_b32 v128, 16, v48
    v_and_b32 v129, s81, v48
    v_mfma_f32_16x16x32_bf16 v[84:87], a[12:15], a[200:203], v[84:87]
    ds_read_b128 a[220:223], v1 offset:16688
    v_lshlrev_b32 v130, 16, v49
    v_and_b32 v131, s81, v49
    v_mfma_f32_16x16x32_bf16 v[92:95], a[12:15], a[204:207], v[92:95]
    v_lshlrev_b32 v132, 16, v50
    v_and_b32 v133, s81, v50
    v_mfma_f32_16x16x32_bf16 v[80:83], a[16:19], a[208:211], v[80:83]
    ds_read_b128 a[224:227], v1 offset:33280
    v_lshlrev_b32 v134, 16, v51
    s_waitcnt lgkmcnt(7)
    v_mfma_f32_16x16x32_bf16 v[88:91], a[16:19], a[212:215], v[88:91]
    v_and_b32 v135, s81, v51
    v_lshlrev_b32 v136, 16, v52
    v_mfma_f32_16x16x32_bf16 v[84:87], a[20:23], a[208:211], v[84:87]
    ds_read_b128 a[228:231], v1 offset:49920
    v_and_b32 v137, s81, v52
    v_mfma_f32_16x16x32_bf16 v[92:95], a[20:23], a[212:215], v[92:95]
    v_lshlrev_b32 v138, 16, v53
    v_and_b32 v139, s81, v53
    s_waitcnt lgkmcnt(4)
    v_mfma_f32_16x16x32_bf16 v[80:83], a[24:27], a[216:219], v[80:83]
    ds_read_b128 a[232:235], v1 offset:33296
    v_lshlrev_b32 v140, 16, v54
    s_waitcnt lgkmcnt(3)
    v_mfma_f32_16x16x32_bf16 v[88:91], a[24:27], a[220:223], v[88:91]
    v_and_b32 v141, s81, v54
    v_lshlrev_b32 v142, 16, v55
    v_mfma_f32_16x16x32_bf16 v[84:87], a[28:31], a[216:219], v[84:87]
    ds_read_b128 a[236:239], v1 offset:49936
    v_and_b32 v143, s81, v55
    v_lshlrev_b32 v144, 16, v56
    v_mfma_f32_16x16x32_bf16 v[92:95], a[28:31], a[220:223], v[92:95]
    v_and_b32 v145, s81, v56
    v_lshlrev_b32 v146, 16, v57
    s_waitcnt lgkmcnt(3)
    v_mfma_f32_16x16x32_bf16 v[112:115], a[0:3], a[224:227], 0
    s_waitcnt lgkmcnt(2)
    v_mfma_f32_16x16x32_bf16 v[120:123], a[0:3], a[228:231], 0
L_N0:
    ds_read_b64 v[14:15], v0 offset:0
    s_waitcnt lgkmcnt(0)
    v_xor_b32 v14, s80, v14
    v_xor_b32 v15, s80, v15
    v_or_b32 v14, v14, v15
    v_cmp_ne_u32 s[62:63], 0, v14
    ds_read_b64 v[14:15], v0 offset:8
    s_waitcnt lgkmcnt(0)
    v_xor_b32 v14, s80, v14
    v_xor_b32 v15, s80, v15
    v_or_b32 v14, v14, v15
    v_cmp_ne_u32 vcc, 0, v14
    s_nop 4
    s_or_b64 vcc, vcc, s[62:63]
    s_cbranch_scc0 L_M0
    ds_read_b128 a[240:243], v1 offset:33312
    v_and_b32 v147, s81, v57
    v_lshlrev_b32 v148, 16, v58
    v_and_b32 v149, s81, v58
    v_mfma_f32_16x16x32_bf16 v[116:119], a[4:7], a[224:227], 0
    ds_read_b128 a[244:247], v1 offset:49952
    s_mov_b32 m0, s58
    s_nop 0
    buffer_load_dword v13, s[8:11], 0 offen sc0 sc1 lds
    v_mfma_f32_16x16x32_bf16 v[124:127], a[4:7], a[228:231], 0
    v_lshlrev_b32 v150, 16, v59
    v_and_b32 v151, s81, v59
    v_lshlrev_b32 v152, 16, v60
    v_mfma_f32_16x16x32_bf16 v[112:115], a[8:11], a[232:235], v[112:115]
    ds_read_b128 a[248:251], v1 offset:33328
    v_and_b32 v153, s81, v60
    v_mfma_f32_16x16x32_bf16 v[120:123], a[8:11], a[236:239], v[120:123]
    v_lshlrev_b32 v154, 16, v61
    v_and_b32 v155, s81, v61
    v_mfma_f32_16x16x32_bf16 v[116:119], a[12:15], a[232:235], v[116:119]
    ds_read_b128 a[252:255], v1 offset:49968
    v_lshlrev_b32 v156, 16, v62
    v_and_b32 v157, s81, v62
    v_mfma_f32_16x16x32_bf16 v[124:127], a[12:15], a[236:239], v[124:127]
    v_lshlrev_b32 v158, 16, v63
    v_and_b32 v159, s81, v63
    s_waitcnt lgkmcnt(3)
    v_mfma_f32_16x16x32_bf16 v[112:115], a[16:19], a[240:243], v[112:115]
    ds_read_b128 a[192:195], v1 offset:64
    ds_read_b128 v[48:51], v2 offset:128
    s_waitcnt lgkmcnt(4)
    v_mfma_f32_16x16x32_bf16 v[120:123], a[16:19], a[244:247], v[120:123]
    ds_read_b128 v[52:55], v2 offset:16768
    ds_read_b128 v[56:59], v2 offset:33408
    v_mfma_f32_16x16x32_bf16 v[116:119], a[20:23], a[240:243], v[116:119]
    ds_read_b128 a[196:199], v1 offset:16704
    ds_read_b128 v[60:63], v2 offset:50048
    s_mov_b32 m0, s58
    s_nop 0
    v_mfma_f32_16x16x32_bf16 v[124:127], a[20:23], a[244:247], v[124:127]
    buffer_load_dword v13, s[8:11], 0 offen sc0 sc1 lds
    v_lshlrev_b32 v160, 16, v64
    v_and_b32 v161, s81, v64
    s_waitcnt lgkmcnt(7)
    v_mfma_f32_16x16x32_bf16 v[112:115], a[24:27], a[248:251], v[112:115]
    ds_read_b128 a[200:203], v1 offset:80
    v_lshlrev_b32 v162, 16, v65
    v_and_b32 v163, s81, v65
    s_waitcnt lgkmcnt(7)
    v_mfma_f32_16x16x32_bf16 v[120:123], a[24:27], a[252:255], v[120:123]
    v_lshlrev_b32 v164, 16, v66
    v_and_b32 v165, s81, v66
    v_mfma_f32_16x16x32_bf16 v[116:119], a[28:31], a[248:251], v[116:119]
    ds_read_b128 a[204:207], v1 offset:16720
    v_lshlrev_b32 v166, 16, v67
    v_mfma_f32_16x16x32_bf16 v[124:127], a[28:31], a[252:255], v[124:127]
    v_and_b32 v167, s81, v67
    v_lshlrev_b32 v168, 16, v68
    s_waitcnt lgkmcnt(7)
    v_mfma_f32_16x16x32_bf16 v[80:83], a[32:35], a[192:195], v[80:83]
    ds_read_b128 a[208:211], v1 offset:96
    v_and_b32 v169, s81, v68
    s_waitcnt lgkmcnt(4)
    v_mfma_f32_16x16x32_bf16 v[88:91], a[32:35], a[196:199], v[88:91]
    v_lshlrev_b32 v170, 16, v69
    v_and_b32 v171, s81, v69
    v_mfma_f32_16x16x32_bf16 v[84:87], a[36:39], a[192:195], v[84:87]
    ds_read_b128 a[212:215], v1 offset:16736
    v_lshlrev_b32 v172, 16, v70
    v_mfma_f32_16x16x32_bf16 v[92:95], a[36:39], a[196:199], v[92:95]
    v_and_b32 v173, s81, v70
    v_lshlrev_b32 v174, 16, v71
    s_waitcnt lgkmcnt(3)
    v_mfma_f32_16x16x32_bf16 v[80:83], a[40:43], a[200:203], v[80:83]
    ds_read_b128 a[216:219], v1 offset:112
    v_and_b32 v175, s81, v71
    v_lshlrev_b32 v176, 16, v72
    s_waitcnt lgkmcnt(3)
    v_mfma_f32_16x16x32_bf16 v[88:91], a[40:43], a[204:207], v[88:91]
    v_and_b32 v177, s81, v72
    v_lshlrev_b32 v178, 16, v73
    v_mfma_f32_16x16x32_bf16 v[84:87], a[44:47], a[200:203], v[84:87]
    ds_read_b128 a[220:223], v1 offset:16752
    v_and_b32 v179, s81, v73
    v_mfma_f32_16x16x32_bf16 v[92:95], a[44:47], a[204:207], v[92:95]
    v_lshlrev_b32 v180, 16, v74
    v_and_b32 v181, s81, v74
    s_waitcnt lgkmcnt(3)
    v_mfma_f32_16x16x32_bf16 v[80:83], a[48:51], a[208:211], v[80:83]
    ds_read_b128 a[224:227], v1 offset:33344
    v_lshlrev_b32 v182, 16, v75
    s_waitcnt lgkmcnt(3)
    v_mfma_f32_16x16x32_bf16 v[88:91], a[48:51], a[212:215], v[88:91]
    v_and_b32 v183, s81, v75
    v_lshlrev_b32 v184, 16, v76
    v_mfma_f32_16x16x32_bf16 v[84:87], a[52:55], a[208:211], v[84:87]
    ds_read_b128 a[228:231], v1 offset:49984
    v_and_b32 v185, s81, v76
    v_mfma_f32_16x16x32_bf16 v[92:95], a[52:55], a[212:215], v[92:95]
    v_lshlrev_b32 v186, 16, v77
    v_and_b32 v187, s81, v77
    s_waitcnt lgkmcnt(3)
    v_mfma_f32_16x16x32_bf16 v[80:83], a[56:59], a[216:219], v[80:83]
    ds_read_b128 a[232:235], v1 offset:33360
    v_lshlrev_b32 v188, 16, v78
    v_and_b32 v189, s81, v78
    s_waitcnt lgkmcnt(3)
    v_mfma_f32_16x16x32_bf16 v[88:91], a[56:59], a[220:223], v[88:91]
    v_lshlrev_b32 v190, 16, v79
    v_and_b32 v191, s81, v79
    v_mfma_f32_16x16x32_bf16 v[84:87], a[60:63], a[216:219], v[84:87]
    ds_read_b128 a[236:239], v1 offset:50000
    ds_read_b128 v[64:67], v2 offset:192
    v_mfma_f32_16x16x32_bf16 v[92:95], a[60:63], a[220:223], v[92:95]
    ds_read_b128 v[68:71], v2 offset:16832
    ds_read_b128 v[72:75], v2 offset:33472
    s_waitcnt lgkmcnt(6)
    v_mfma_f32_16x16x32_bf16 v[112:115], a[32:35], a[224:227], v[112:115]
    s_waitcnt lgkmcnt(5)
    v_mfma_f32_16x16x32_bf16 v[120:123], a[32:35], a[228:231], v[120:123]
L_N1:
    ds_read_b64 v[14:15], v0 offset:0
    s_waitcnt lgkmcnt(0)
    v_xor_b32 v14, s80, v14
    v_xor_b32 v15, s80, v15
    v_or_b32 v14, v14, v15
    v_cmp_ne_u32 s[62:63], 0, v14
    ds_read_b64 v[14:15], v0 offset:8
    s_waitcnt lgkmcnt(0)
    v_xor_b32 v14, s80, v14
    v_xor_b32 v15, s80, v15
    v_or_b32 v14, v14, v15
    v_cmp_ne_u32 vcc, 0, v14
    s_nop 4
    s_or_b64 vcc, vcc, s[62:63]
    s_cbranch_scc0 L_B1
    ds_read_b128 a[240:243], v1 offset:33376
    ds_read_b128 v[76:79], v2 offset:50112
    v_lshlrev_b32 v192, 16, v48
    v_and_b32 v193, s81, v48
    v_mfma_f32_16x16x32_bf16 v[116:119], a[36:39], a[224:227], v[116:119]
    ds_read_b128 a[244:247], v1 offset:50016
    s_mov_b32 m0, s58
    s_nop 0
    buffer_load_dword v13, s[8:11], 0 offen sc0 sc1 lds
    v_mfma_f32_16x16x32_bf16 v[124:127], a[36:39], a[228:231], v[124:127]
    v_lshlrev_b32 v194, 16, v49
    v_and_b32 v195, s81, v49
    v_lshlrev_b32 v196, 16, v50
    v_and_b32 v197, s81, v50
    v_mfma_f32_16x16x32_bf16 v[112:115], a[40:43], a[232:235], v[112:115]
    ds_read_b128 a[248:251], v1 offset:33392
    v_lshlrev_b32 v198, 16, v51
    v_mfma_f32_16x16x32_bf16 v[120:123], a[40:43], a[236:239], v[120:123]
    v_and_b32 v199, s81, v51
    v_lshlrev_b32 v200, 16, v52
    v_mfma_f32_16x16x32_bf16 v[116:119], a[44:47], a[232:235], v[116:119]
    ds_read_b128 a[252:255], v1 offset:50032
    v_and_b32 v201, s81, v52
    v_mfma_f32_16x16x32_bf16 v[124:127], a[44:47], a[236:239], v[124:127]
    v_lshlrev_b32 v202, 16, v53
    v_and_b32 v203, s81, v53
    s_waitcnt lgkmcnt(4)
    v_mfma_f32_16x16x32_bf16 v[112:115], a[48:51], a[240:243], v[112:115]
    ds_read_b128 a[192:195], v1 offset:128
    v_lshlrev_b32 v204, 16, v54
    s_waitcnt lgkmcnt(3)
    v_mfma_f32_16x16x32_bf16 v[120:123], a[48:51], a[244:247], v[120:123]
    v_and_b32 v205, s81, v54
    v_lshlrev_b32 v206, 16, v55
    v_mfma_f32_16x16x32_bf16 v[116:119], a[52:55], a[240:243], v[116:119]
    ds_read_b128 a[196:199], v1 offset:16768
    s_mov_b32 m0, s58
    s_nop 0
    buffer_load_dword v13, s[8:11], 0 offen sc0 sc1 lds
    v_mfma_f32_16x16x32_bf16 v[124:127], a[52:55], a[244:247], v[124:127]
    v_and_b32 v207, s81, v55
    v_lshlrev_b32 v208, 16, v56
    v_and_b32 v209, s81, v56
    v_lshlrev_b32 v210, 16, v57
    s_waitcnt lgkmcnt(3)
    v_mfma_f32_16x16x32_bf16 v[112:115], a[56:59], a[248:251], v[112:115]
    ds_read_b128 a[200:203], v1 offset:144
    v_and_b32 v211, s81, v57
    s_waitcnt lgkmcnt(3)
    v_mfma_f32_16x16x32_bf16 v[120:123], a[56:59], a[252:255], v[120:123]
    v_lshlrev_b32 v212, 16, v58
    v_and_b32 v213, s81, v58
    v_mfma_f32_16x16x32_bf16 v[116:119], a[60:63], a[248:251], v[116:119]
    ds_read_b128 a[204:207], v1 offset:16784
    v_lshlrev_b32 v214, 16, v59
    v_mfma_f32_16x16x32_bf16 v[124:127], a[60:63], a[252:255], v[124:127]
    v_and_b32 v215, s81, v59
    v_lshlrev_b32 v216, 16, v60
    s_waitcnt lgkmcnt(3)
    v_mfma_f32_16x16x32_bf16 v[80:83], a[64:67], a[192:195], v[80:83]
    ds_read_b128 a[208:211], v1 offset:160
    v_and_b32 v217, s81, v60
    s_waitcnt lgkmcnt(3)
    v_mfma_f32_16x16x32_bf16 v[88:91], a[64:67], a[196:199], v[88:91]
    v_lshlrev_b32 v218, 16, v61
    v_and_b32 v219, s81, v61
    v_mfma_f32_16x16x32_bf16 v[84:87], a[68:71], a[192:195], v[84:87]
    ds_read_b128 a[212:215], v1 offset:16800
    v_lshlrev_b32 v220, 16, v62
    v_and_b32 v221, s81, v62
    v_mfma_f32_16x16x32_bf16 v[92:95], a[68:71], a[196:199], v[92:95]
    v_lshlrev_b32 v222, 16, v63
    v_and_b32 v223, s81, v63
    s_waitcnt lgkmcnt(3)
    v_mfma_f32_16x16x32_bf16 v[80:83], a[72:75], a[200:203], v[80:83]
    ds_read_b128 a[216:219], v1 offset:176
    v_lshlrev_b32 v224, 16, v64
    s_waitcnt lgkmcnt(3)
    v_mfma_f32_16x16x32_bf16 v[88:91], a[72:75], a[204:207], v[88:91]
    v_and_b32 v225, s81, v64
    v_lshlrev_b32 v226, 16, v65
    v_mfma_f32_16x16x32_bf16 v[84:87], a[76:79], a[200:203], v[84:87]
    ds_read_b128 a[220:223], v1 offset:16816
    v_and_b32 v227, s81, v65
    v_mfma_f32_16x16x32_bf16 v[92:95], a[76:79], a[204:207], v[92:95]
    v_lshlrev_b32 v228, 16, v66
    v_and_b32 v229, s81, v66
    s_waitcnt lgkmcnt(3)
    v_mfma_f32_16x16x32_bf16 v[80:83], a[80:83], a[208:211], v[80:83]
    ds_read_b128 a[224:227], v1 offset:192
    v_lshlrev_b32 v230, 16, v67
    v_and_b32 v231, s81, v67
    s_waitcnt lgkmcnt(3)
    v_mfma_f32_16x16x32_bf16 v[88:91], a[80:83], a[212:215], v[88:91]
    v_lshlrev_b32 v232, 16, v68
    v_and_b32 v233, s81, v68
    v_mfma_f32_16x16x32_bf16 v[84:87], a[84:87], a[208:211], v[84:87]
    ds_read_b128 a[228:231], v1 offset:16832
    v_lshlrev_b32 v234, 16, v69
    v_mfma_f32_16x16x32_bf16 v[92:95], a[84:87], a[212:215], v[92:95]
    v_and_b32 v235, s81, v69
    v_lshlrev_b32 v236, 16, v70
    s_waitcnt lgkmcnt(3)
    v_mfma_f32_16x16x32_bf16 v[80:83], a[88:91], a[216:219], v[80:83]
    ds_read_b128 a[232:235], v1 offset:208
    v_and_b32 v237, s81, v70
    s_waitcnt lgkmcnt(3)
    v_mfma_f32_16x16x32_bf16 v[88:91], a[88:91], a[220:223], v[88:91]
    v_lshlrev_b32 v238, 16, v71
    v_and_b32 v239, s81, v71
    v_mfma_f32_16x16x32_bf16 v[84:87], a[92:95], a[216:219], v[84:87]
    ds_read_b128 a[236:239], v1 offset:16848
    v_lshlrev_b32 v240, 16, v72
    v_mfma_f32_16x16x32_bf16 v[92:95], a[92:95], a[220:223], v[92:95]
    v_and_b32 v241, s81, v72
    v_lshlrev_b32 v242, 16, v73
    s_waitcnt lgkmcnt(3)
    v_mfma_f32_16x16x32_bf16 v[80:83], a[96:99], a[224:227], v[80:83]
    ds_read_b128 a[240:243], v1 offset:224
    v_and_b32 v243, s81, v73
    v_lshlrev_b32 v244, 16, v74
    s_waitcnt lgkmcnt(3)
    v_mfma_f32_16x16x32_bf16 v[88:91], a[96:99], a[228:231], v[88:91]
    v_and_b32 v245, s81, v74
    v_lshlrev_b32 v246, 16, v75
    v_mfma_f32_16x16x32_bf16 v[84:87], a[100:103], a[224:227], v[84:87]
    ds_read_b128 a[244:247], v1 offset:16864
    v_and_b32 v247, s81, v75
    v_mfma_f32_16x16x32_bf16 v[92:95], a[100:103], a[228:231], v[92:95]
    v_lshlrev_b32 v248, 16, v76
    v_and_b32 v249, s81, v76
    s_waitcnt lgkmcnt(3)
    v_mfma_f32_16x16x32_bf16 v[80:83], a[104:107], a[232:235], v[80:83]
    ds_read_b128 a[248:251], v1 offset:240
    v_lshlrev_b32 v250, 16, v77
    s_waitcnt lgkmcnt(3)
    v_mfma_f32_16x16x32_bf16 v[88:91], a[104:107], a[236:239], v[88:91]
    v_and_b32 v251, s81, v77
    v_lshlrev_b32 v252, 16, v78
    v_mfma_f32_16x16x32_bf16 v[84:87], a[108:111], a[232:235], v[84:87]
    ds_read_b128 a[252:255], v1 offset:16880
    v_and_b32 v253, s81, v78
    v_mfma_f32_16x16x32_bf16 v[92:95], a[108:111], a[236:239], v[92:95]
    v_lshlrev_b32 v254, 16, v79
    v_and_b32 v255, s81, v79
    s_waitcnt lgkmcnt(3)
    v_mfma_f32_16x16x32_bf16 v[80:83], a[112:115], a[240:243], v[80:83]
    ds_read_b128 a[192:195], v1 offset:33408
    s_waitcnt lgkmcnt(3)
    v_mfma_f32_16x16x32_bf16 v[88:91], a[112:115], a[244:247], v[88:91]
    v_mfma_f32_16x16x32_bf16 v[84:87], a[116:119], a[240:243], v[84:87]
    ds_read_b128 a[196:199], v1 offset:50048
    v_mfma_f32_16x16x32_bf16 v[92:95], a[116:119], a[244:247], v[92:95]
    s_waitcnt lgkmcnt(3)
    v_mfma_f32_16x16x32_bf16 v[80:83], a[120:123], a[248:251], v[80:83]
    ds_read_b128 a[200:203], v1 offset:33424
    s_waitcnt lgkmcnt(3)
    v_mfma_f32_16x16x32_bf16 v[88:91], a[120:123], a[252:255], v[88:91]
    v_mfma_f32_16x16x32_bf16 v[84:87], a[124:127], a[248:251], v[84:87]
    ds_read_b128 a[204:207], v1 offset:50064
    v_mfma_f32_16x16x32_bf16 v[92:95], a[124:127], a[252:255], v[92:95]
    s_waitcnt lgkmcnt(3)
    v_mfma_f32_16x16x32_bf16 v[112:115], a[64:67], a[192:195], v[112:115]
    s_waitcnt lgkmcnt(2)
    v_mfma_f32_16x16x32_bf16 v[120:123], a[64:67], a[196:199], v[120:123]
L_N2:
    ds_read_b64 v[14:15], v0 offset:0
    s_waitcnt lgkmcnt(0)
    v_xor_b32 v14, s80, v14
    v_xor_b32 v15, s80, v15
    v_or_b32 v14, v14, v15
    v_cmp_ne_u32 s[62:63], 0, v14
    ds_read_b64 v[14:15], v0 offset:8
    s_waitcnt lgkmcnt(0)
    v_xor_b32 v14, s80, v14
    v_xor_b32 v15, s80, v15
    v_or_b32 v14, v14, v15
    v_cmp_ne_u32 vcc, 0, v14
    s_nop 4
    s_or_b64 vcc, vcc, s[62:63]
    s_cbranch_scc0 L_B2
    ds_read_b128 a[208:211], v1 offset:33440
    v_mfma_f32_16x16x32_bf16 v[116:119], a[68:71], a[192:195], v[116:119]
    ds_read_b128 a[212:215], v1 offset:50080
    s_mov_b32 m0, s58
    v_mfma_f32_16x16x32_bf16 v[124:127], a[68:71], a[196:199], v[124:127]
    s_nop 0
    buffer_load_dword v13, s[8:11], 0 offen sc0 sc1 lds
    v_mfma_f32_16x16x32_bf16 v[112:115], a[72:75], a[200:203], v[112:115]
    ds_read_b128 a[216:219], v1 offset:33456
    v_cvt_pk_bf16_f32 v80, v80, v81
    v_cvt_pk_bf16_f32 v81, v82, v83
    v_mfma_f32_16x16x32_bf16 v[120:123], a[72:75], a[204:207], v[120:123]
    v_cvt_pk_bf16_f32 v82, v84, v85
    v_cvt_pk_bf16_f32 v83, v86, v87
    v_mfma_f32_16x16x32_bf16 v[116:119], a[76:79], a[200:203], v[116:119]
    ds_read_b128 a[220:223], v1 offset:50096
    ds_write_b128 v4, v[80:83] offset:0
    v_cvt_pk_bf16_f32 v84, v88, v89
    v_mfma_f32_16x16x32_bf16 v[124:127], a[76:79], a[204:207], v[124:127]
    v_cvt_pk_bf16_f32 v85, v90, v91
    v_cvt_pk_bf16_f32 v86, v92, v93
    v_cvt_pk_bf16_f32 v87, v94, v95
    s_waitcnt lgkmcnt(4)
    v_mfma_f32_16x16x32_bf16 v[112:115], a[80:83], a[208:211], v[112:115]
    s_waitcnt lgkmcnt(3)
    v_mfma_f32_16x16x32_bf16 v[120:123], a[80:83], a[212:215], v[120:123]
    v_mfma_f32_16x16x32_bf16 v[116:119], a[84:87], a[208:211], v[116:119]
    ds_read_b128 a[224:227], v1 offset:33472
    ds_read_b128 v[16:19], v5 offset:0
    ds_read_b128 a[228:231], v1 offset:50112
    ds_read_b128 v[20:23], v5 offset:16
    v_mfma_f32_16x16x32_bf16 v[124:127], a[84:87], a[212:215], v[124:127]
    s_mov_b32 m0, s58
    s_nop 0
    buffer_load_dword v13, s[8:11], 0 offen sc0 sc1 lds
    ds_write_b128 v4, v[84:87] offset:1280
    s_waitcnt lgkmcnt(7)
    v_mfma_f32_16x16x32_bf16 v[112:115], a[88:91], a[216:219], v[112:115]
    s_waitcnt lgkmcnt(6)
    v_mfma_f32_16x16x32_bf16 v[120:123], a[88:91], a[220:223], v[120:123]
    v_mfma_f32_16x16x32_bf16 v[116:119], a[92:95], a[216:219], v[116:119]
    s_waitcnt lgkmcnt(0)
    s_barrier
    ds_read_b128 a[232:235], v1 offset:33488
    v_mfma_f32_16x16x32_bf16 v[124:127], a[92:95], a[220:223], v[124:127]
    ds_read_b128 a[236:239], v1 offset:50128
    v_mfma_f32_16x16x32_bf16 v[112:115], a[96:99], a[224:227], v[112:115]
    ds_read_b128 a[240:243], v1 offset:33504
    ds_read_b128 a[128:131], v3 offset:0
    v_mfma_f32_16x16x32_bf16 v[120:123], a[96:99], a[228:231], v[120:123]
    ds_read_b128 a[132:135], v3 offset:1280
    v_mfma_f32_16x16x32_bf16 v[116:119], a[100:103], a[224:227], v[116:119]
    ds_read_b128 a[244:247], v1 offset:50144
    v_mfma_f32_16x16x32_bf16 v[124:127], a[100:103], a[228:231], v[124:127]
    ds_read_b128 a[136:139], v3 offset:16
    s_waitcnt lgkmcnt(6)
    v_mfma_f32_16x16x32_bf16 v[112:115], a[104:107], a[232:235], v[112:115]
    ds_read_b128 a[248:251], v1 offset:33520
    s_waitcnt lgkmcnt(6)
    v_mfma_f32_16x16x32_bf16 v[120:123], a[104:107], a[236:239], v[120:123]
    ds_read_b128 a[140:143], v3 offset:1296
    v_mfma_f32_16x16x32_bf16 v[116:119], a[108:111], a[232:235], v[116:119]
    ds_read_b128 a[252:255], v1 offset:50160
    v_mfma_f32_16x16x32_bf16 v[124:127], a[108:111], a[236:239], v[124:127]
    ds_read_b128 a[144:147], v3 offset:32
    s_waitcnt lgkmcnt(8)
    v_mfma_f32_16x16x32_bf16 v[112:115], a[112:115], a[240:243], v[112:115]
    ds_read_b128 a[148:151], v3 offset:1312
    s_waitcnt lgkmcnt(6)
    v_mfma_f32_16x16x32_bf16 v[120:123], a[112:115], a[244:247], v[120:123]
    v_mfma_f32_16x16x32_bf16 v[116:119], a[116:119], a[240:243], v[116:119]
    ds_read_b128 a[152:155], v3 offset:48
    v_mfma_f32_16x16x32_bf16 v[124:127], a[116:119], a[244:247], v[124:127]
    s_waitcnt lgkmcnt(5)
    v_mfma_f32_16x16x32_bf16 v[112:115], a[120:123], a[248:251], v[112:115]
    ds_read_b128 a[156:159], v3 offset:1328
    s_waitcnt lgkmcnt(4)
    v_mfma_f32_16x16x32_bf16 v[120:123], a[120:123], a[252:255], v[120:123]
    v_mfma_f32_16x16x32_bf16 v[116:119], a[124:127], a[248:251], v[116:119]
    v_mfma_f32_16x16x32_bf16 v[124:127], a[124:127], a[252:255], v[124:127]
    s_branch L_Nend
L_B1:
    buffer_load_dwordx4 a[0:3], v6, s[8:11], s21 offen offset:0
    buffer_load_dwordx4 a[4:7], v6, s[8:11], s21 offen offset:1024
    buffer_load_dwordx4 a[8:11], v6, s[8:11], s21 offen offset:2048
    buffer_load_dwordx4 a[12:15], v6, s[8:11], s21 offen offset:3072
    s_add_u32 s21, s21, 4096
    buffer_load_dwordx4 a[16:19], v6, s[8:11], s21 offen offset:0
    buffer_load_dwordx4 a[20:23], v6, s[8:11], s21 offen offset:1024
    buffer_load_dwordx4 a[24:27], v6, s[8:11], s21 offen offset:2048
    buffer_load_dwordx4 a[28:31], v6, s[8:11], s21 offen offset:3072
    s_add_u32 s21, s21, 4096
    s_branch L_M1
L_B2:
    buffer_load_dwordx4 a[0:3], v6, s[8:11], s21 offen offset:0
    buffer_load_dwordx4 a[4:7], v6, s[8:11], s21 offen offset:1024
    buffer_load_dwordx4 a[8:11], v6, s[8:11], s21 offen offset:2048
    buffer_load_dwordx4 a[12:15], v6, s[8:11], s21 offen offset:3072
    s_add_u32 s21, s21, 4096
    buffer_load_dwordx4 a[16:19], v6, s[8:11], s21 offen offset:0
    buffer_load_dwordx4 a[20:23], v6, s[8:11], s21 offen offset:1024
    buffer_load_dwordx4 a[24:27], v6, s[8:11], s21 offen offset:2048
    buffer_load_dwordx4 a[28:31], v6, s[8:11], s21 offen offset:3072
    s_add_u32 s21, s21, 4096
    buffer_load_dwordx4 a[32:35], v6, s[8:11], s21 offen offset:0
    buffer_load_dwordx4 a[36:39], v6, s[8:11], s21 offen offset:1024
    buffer_load_dwordx4 a[40:43], v6, s[8:11], s21 offen offset:2048
    buffer_load_dwordx4 a[44:47], v6, s[8:11], s21 offen offset:3072
    s_add_u32 s21, s21, 4096
    buffer_load_dwordx4 a[48:51], v6, s[8:11], s21 offen offset:0
    buffer_load_dwordx4 a[52:55], v6, s[8:11], s21 offen offset:1024
    buffer_load_dwordx4 a[56:59], v6, s[8:11], s21 offen offset:2048
    buffer_load_dwordx4 a[60:63], v6, s[8:11], s21 offen offset:3072
    s_add_u32 s21, s21, 4096
    s_branch L_M2
L_B3:
    buffer_load_dwordx4 a[0:3], v6, s[8:11], s21 offen offset:0
    buffer_load_dwordx4 a[4:7], v6, s[8:11], s21 offen offset:1024
    buffer_load_dwordx4 a[8:11], v6, s[8:11], s21 offen offset:2048
    buffer_load_dwordx4 a[12:15], v6, s[8:11], s21 offen offset:3072
    s_add_u32 s21, s21, 4096
    buffer_load_dwordx4 a[16:19], v6, s[8:11], s21 offen offset:0
    buffer_load_dwordx4 a[20:23], v6, s[8:11], s21 offen offset:1024
    buffer_load_dwordx4 a[24:27], v6, s[8:11], s21 offen offset:2048
    buffer_load_dwordx4 a[28:31], v6, s[8:11], s21 offen offset:3072
    s_add_u32 s21, s21, 4096
    buffer_load_dwordx4 a[32:35], v6, s[8:11], s21 offen offset:0
    buffer_load_dwordx4 a[36:39], v6, s[8:11], s21 offen offset:1024
    buffer_load_dwordx4 a[40:43], v6, s[8:11], s21 offen offset:2048
    buffer_load_dwordx4 a[44:47], v6, s[8:11], s21 offen offset:3072
    s_add_u32 s21, s21, 4096
    buffer_load_dwordx4 a[48:51], v6, s[8:11], s21 offen offset:0
    buffer_load_dwordx4 a[52:55], v6, s[8:11], s21 offen offset:1024
    buffer_load_dwordx4 a[56:59], v6, s[8:11], s21 offen offset:2048
    buffer_load_dwordx4 a[60:63], v6, s[8:11], s21 offen offset:3072
    s_add_u32 s21, s21, 4096
    buffer_load_dwordx4 a[64:67], v6, s[8:11], s21 offen offset:0
    buffer_load_dwordx4 a[68:71], v6, s[8:11], s21 offen offset:1024
    buffer_load_dwordx4 a[72:75], v6, s[8:11], s21 offen offset:2048
    buffer_load_dwordx4 a[76:79], v6, s[8:11], s21 offen offset:3072
    s_add_u32 s21, s21, 4096
    buffer_load_dwordx4 a[80:83], v6, s[8:11], s21 offen offset:0
    buffer_load_dwordx4 a[84:87], v6, s[8:11], s21 offen offset:1024
    buffer_load_dwordx4 a[88:91], v6, s[8:11], s21 offen offset:2048
    buffer_load_dwordx4 a[92:95], v6, s[8:11], s21 offen offset:3072
    s_add_u32 s21, s21, 4096
    s_branch L_Ftop
L_M0:
    ds_read_b128 a[240:243], v1 offset:33312
    buffer_load_dwordx4 a[0:3], v6, s[8:11], s21 offen offset:0
    v_and_b32 v147, s81, v57
    v_lshlrev_b32 v148, 16, v58
    v_and_b32 v149, s81, v58
    v_mfma_f32_16x16x32_bf16 v[116:119], a[4:7], a[224:227], 0
    ds_read_b128 a[244:247], v1 offset:49952
    v_mfma_f32_16x16x32_bf16 v[124:127], a[4:7], a[228:231], 0
    buffer_load_dwordx4 a[4:7], v6, s[8:11], s21 offen offset:1024
    v_lshlrev_b32 v150, 16, v59
    v_and_b32 v151, s81, v59
    v_lshlrev_b32 v152, 16, v60
    v_mfma_f32_16x16x32_bf16 v[112:115], a[8:11], a[232:235], v[112:115]
    ds_read_b128 a[248:251], v1 offset:33328
    v_mfma_f32_16x16x32_bf16 v[120:123], a[8:11], a[236:239], v[120:123]
    buffer_load_dwordx4 a[8:11], v6, s[8:11], s21 offen offset:2048
    v_and_b32 v153, s81, v60
    v_lshlrev_b32 v154, 16, v61
    v_and_b32 v155, s81, v61
    v_mfma_f32_16x16x32_bf16 v[116:119], a[12:15], a[232:235], v[116:119]
    ds_read_b128 a[252:255], v1 offset:49968
    v_mfma_f32_16x16x32_bf16 v[124:127], a[12:15], a[236:239], v[124:127]
    buffer_load_dwordx4 a[12:15], v6, s[8:11], s21 offen offset:3072
    s_add_u32 s21, s21, 4096
    v_lshlrev_b32 v156, 16, v62
    v_and_b32 v157, s81, v62
    v_lshlrev_b32 v158, 16, v63
    v_and_b32 v159, s81, v63
    s_waitcnt lgkmcnt(3)
    v_mfma_f32_16x16x32_bf16 v[112:115], a[16:19], a[240:243], v[112:115]
    ds_read_b128 a[192:195], v1 offset:64
    ds_read_b128 v[48:51], v2 offset:128
    ds_read_b128 v[52:55], v2 offset:16768
    s_waitcnt lgkmcnt(5)
    v_mfma_f32_16x16x32_bf16 v[120:123], a[16:19], a[244:247], v[120:123]
    ds_read_b128 v[56:59], v2 offset:33408
    buffer_load_dwordx4 a[16:19], v6, s[8:11], s21 offen offset:0
    v_mfma_f32_16x16x32_bf16 v[116:119], a[20:23], a[240:243], v[116:119]
    ds_read_b128 a[196:199], v1 offset:16704
    ds_read_b128 v[60:63], v2 offset:50048
    v_mfma_f32_16x16x32_bf16 v[124:127], a[20:23], a[244:247], v[124:127]
    buffer_load_dwordx4 a[20:23], v6, s[8:11], s21 offen offset:1024
    v_lshlrev_b32 v160, 16, v64
    v_and_b32 v161, s81, v64
    s_waitcnt lgkmcnt(7)
    v_mfma_f32_16x16x32_bf16 v[112:115], a[24:27], a[248:251], v[112:115]
    ds_read_b128 a[200:203], v1 offset:80
    s_waitcnt lgkmcnt(7)
    v_mfma_f32_16x16x32_bf16 v[120:123], a[24:27], a[252:255], v[120:123]
    buffer_load_dwordx4 a[24:27], v6, s[8:11], s21 offen offset:2048
    v_lshlrev_b32 v162, 16, v65
    v_and_b32 v163, s81, v65
    v_lshlrev_b32 v164, 16, v66
    v_and_b32 v165, s81, v66
    v_mfma_f32_16x16x32_bf16 v[116:119], a[28:31], a[248:251], v[116:119]
    ds_read_b128 a[204:207], v1 offset:16720
    v_mfma_f32_16x16x32_bf16 v[124:127], a[28:31], a[252:255], v[124:127]
    buffer_load_dwordx4 a[28:31], v6, s[8:11], s21 offen offset:3072
    s_add_u32 s21, s21, 4096
    v_lshlrev_b32 v166, 16, v67
    v_and_b32 v167, s81, v67
    v_lshlrev_b32 v168, 16, v68
    s_waitcnt lgkmcnt(7)
    v_mfma_f32_16x16x32_bf16 v[80:83], a[32:35], a[192:195], v[80:83]
    ds_read_b128 a[208:211], v1 offset:96
    v_and_b32 v169, s81, v68
    s_waitcnt lgkmcnt(4)
    v_mfma_f32_16x16x32_bf16 v[88:91], a[32:35], a[196:199], v[88:91]
    v_lshlrev_b32 v170, 16, v69
    v_and_b32 v171, s81, v69
    v_mfma_f32_16x16x32_bf16 v[84:87], a[36:39], a[192:195], v[84:87]
    ds_read_b128 a[212:215], v1 offset:16736
    v_lshlrev_b32 v172, 16, v70
    v_mfma_f32_16x16x32_bf16 v[92:95], a[36:39], a[196:199], v[92:95]
    v_and_b32 v173, s81, v70
    v_lshlrev_b32 v174, 16, v71
    s_waitcnt lgkmcnt(3)
    v_mfma_f32_16x16x32_bf16 v[80:83], a[40:43], a[200:203], v[80:83]
    ds_read_b128 a[216:219], v1 offset:112
    v_and_b32 v175, s81, v71
    v_lshlrev_b32 v176, 16, v72
    s_waitcnt lgkmcnt(3)
    v_mfma_f32_16x16x32_bf16 v[88:91], a[40:43], a[204:207], v[88:91]
    v_and_b32 v177, s81, v72
    v_lshlrev_b32 v178, 16, v73
    v_mfma_f32_16x16x32_bf16 v[84:87], a[44:47], a[200:203], v[84:87]
    ds_read_b128 a[220:223], v1 offset:16752
    v_and_b32 v179, s81, v73
    v_mfma_f32_16x16x32_bf16 v[92:95], a[44:47], a[204:207], v[92:95]
    v_lshlrev_b32 v180, 16, v74
    v_and_b32 v181, s81, v74
    s_waitcnt lgkmcnt(3)
    v_mfma_f32_16x16x32_bf16 v[80:83], a[48:51], a[208:211], v[80:83]
    ds_read_b128 a[224:227], v1 offset:33344
    v_lshlrev_b32 v182, 16, v75
    s_waitcnt lgkmcnt(3)
    v_mfma_f32_16x16x32_bf16 v[88:91], a[48:51], a[212:215], v[88:91]
    v_and_b32 v183, s81, v75
    v_lshlrev_b32 v184, 16, v76
    v_mfma_f32_16x16x32_bf16 v[84:87], a[52:55], a[208:211], v[84:87]
    ds_read_b128 a[228:231], v1 offset:49984
    v_and_b32 v185, s81, v76
    v_mfma_f32_16x16x32_bf16 v[92:95], a[52:55], a[212:215], v[92:95]
    v_lshlrev_b32 v186, 16, v77
    v_and_b32 v187, s81, v77
    s_waitcnt lgkmcnt(3)
    v_mfma_f32_16x16x32_bf16 v[80:83], a[56:59], a[216:219], v[80:83]
    ds_read_b128 a[232:235], v1 offset:33360
    v_lshlrev_b32 v188, 16, v78
    v_and_b32 v189, s81, v78
    s_waitcnt lgkmcnt(3)
    v_mfma_f32_16x16x32_bf16 v[88:91], a[56:59], a[220:223], v[88:91]
    v_lshlrev_b32 v190, 16, v79
    v_and_b32 v191, s81, v79
    v_mfma_f32_16x16x32_bf16 v[84:87], a[60:63], a[216:219], v[84:87]
    ds_read_b128 a[236:239], v1 offset:50000
    ds_read_b128 v[64:67], v2 offset:192
    v_mfma_f32_16x16x32_bf16 v[92:95], a[60:63], a[220:223], v[92:95]
    ds_read_b128 v[68:71], v2 offset:16832
    ds_read_b128 v[72:75], v2 offset:33472
    s_waitcnt lgkmcnt(6)
    v_mfma_f32_16x16x32_bf16 v[112:115], a[32:35], a[224:227], v[112:115]
    s_waitcnt lgkmcnt(5)
    v_mfma_f32_16x16x32_bf16 v[120:123], a[32:35], a[228:231], v[120:123]
L_M1:
    ds_read_b128 a[240:243], v1 offset:33376
    ds_read_b128 v[76:79], v2 offset:50112
    buffer_load_dwordx4 a[32:35], v6, s[8:11], s21 offen offset:0
    v_lshlrev_b32 v192, 16, v48
    v_and_b32 v193, s81, v48
    v_mfma_f32_16x16x32_bf16 v[116:119], a[36:39], a[224:227], v[116:119]
    ds_read_b128 a[244:247], v1 offset:50016
    v_mfma_f32_16x16x32_bf16 v[124:127], a[36:39], a[228:231], v[124:127]
    buffer_load_dwordx4 a[36:39], v6, s[8:11], s21 offen offset:1024
    v_lshlrev_b32 v194, 16, v49
    v_and_b32 v195, s81, v49
    v_lshlrev_b32 v196, 16, v50
    v_and_b32 v197, s81, v50
    s_waitcnt lgkmcnt(7)
    v_mfma_f32_16x16x32_bf16 v[112:115], a[40:43], a[232:235], v[112:115]
    ds_read_b128 a[248:251], v1 offset:33392
    s_waitcnt lgkmcnt(7)
    v_mfma_f32_16x16x32_bf16 v[120:123], a[40:43], a[236:239], v[120:123]
    buffer_load_dwordx4 a[40:43], v6, s[8:11], s21 offen offset:2048
    v_lshlrev_b32 v198, 16, v51
    v_and_b32 v199, s81, v51
    v_lshlrev_b32 v200, 16, v52
    v_mfma_f32_16x16x32_bf16 v[116:119], a[44:47], a[232:235], v[116:119]
    ds_read_b128 a[252:255], v1 offset:50032
    v_mfma_f32_16x16x32_bf16 v[124:127], a[44:47], a[236:239], v[124:127]
    buffer_load_dwordx4 a[44:47], v6, s[8:11], s21 offen offset:3072
    s_add_u32 s21, s21, 4096
    v_and_b32 v201, s81, v52
    v_lshlrev_b32 v202, 16, v53
    v_and_b32 v203, s81, v53
    s_waitcnt lgkmcnt(4)
    v_mfma_f32_16x16x32_bf16 v[112:115], a[48:51], a[240:243], v[112:115]
    ds_read_b128 a[192:195], v1 offset:128
    s_waitcnt lgkmcnt(3)
    v_mfma_f32_16x16x32_bf16 v[120:123], a[48:51], a[244:247], v[120:123]
    buffer_load_dwordx4 a[48:51], v6, s[8:11], s21 offen offset:0
    v_lshlrev_b32 v204, 16, v54
    v_and_b32 v205, s81, v54
    v_lshlrev_b32 v206, 16, v55
    v_mfma_f32_16x16x32_bf16 v[116:119], a[52:55], a[240:243], v[116:119]
    ds_read_b128 a[196:199], v1 offset:16768
    v_mfma_f32_16x16x32_bf16 v[124:127], a[52:55], a[244:247], v[124:127]
    buffer_load_dwordx4 a[52:55], v6, s[8:11], s21 offen offset:1024
    v_and_b32 v207, s81, v55
    v_lshlrev_b32 v208, 16, v56
    v_and_b32 v209, s81, v56
    v_lshlrev_b32 v210, 16, v57
    s_waitcnt lgkmcnt(3)
    v_mfma_f32_16x16x32_bf16 v[112:115], a[56:59], a[248:251], v[112:115]
    ds_read_b128 a[200:203], v1 offset:144
    s_waitcnt lgkmcnt(3)
    v_mfma_f32_16x16x32_bf16 v[120:123], a[56:59], a[252:255], v[120:123]
    buffer_load_dwordx4 a[56:59], v6, s[8:11], s21 offen offset:2048
    v_and_b32 v211, s81, v57
    v_lshlrev_b32 v212, 16, v58
    v_and_b32 v213, s81, v58
    v_mfma_f32_16x16x32_bf16 v[116:119], a[60:63], a[248:251], v[116:119]
    ds_read_b128 a[204:207], v1 offset:16784
    v_mfma_f32_16x16x32_bf16 v[124:127], a[60:63], a[252:255], v[124:127]
    buffer_load_dwordx4 a[60:63], v6, s[8:11], s21 offen offset:3072
    s_add_u32 s21, s21, 4096
    v_lshlrev_b32 v214, 16, v59
    v_and_b32 v215, s81, v59
    v_lshlrev_b32 v216, 16, v60
    s_waitcnt lgkmcnt(3)
    v_mfma_f32_16x16x32_bf16 v[80:83], a[64:67], a[192:195], v[80:83]
    ds_read_b128 a[208:211], v1 offset:160
    v_and_b32 v217, s81, v60
    s_waitcnt lgkmcnt(3)
    v_mfma_f32_16x16x32_bf16 v[88:91], a[64:67], a[196:199], v[88:91]
    v_lshlrev_b32 v218, 16, v61
    v_and_b32 v219, s81, v61
    v_mfma_f32_16x16x32_bf16 v[84:87], a[68:71], a[192:195], v[84:87]
    ds_read_b128 a[212:215], v1 offset:16800
    v_lshlrev_b32 v220, 16, v62
    v_and_b32 v221, s81, v62
    v_mfma_f32_16x16x32_bf16 v[92:95], a[68:71], a[196:199], v[92:95]
    v_lshlrev_b32 v222, 16, v63
    v_and_b32 v223, s81, v63
    s_waitcnt lgkmcnt(3)
    v_mfma_f32_16x16x32_bf16 v[80:83], a[72:75], a[200:203], v[80:83]
    ds_read_b128 a[216:219], v1 offset:176
    v_lshlrev_b32 v224, 16, v64
    s_waitcnt lgkmcnt(3)
    v_mfma_f32_16x16x32_bf16 v[88:91], a[72:75], a[204:207], v[88:91]
    v_and_b32 v225, s81, v64
    v_lshlrev_b32 v226, 16, v65
    v_mfma_f32_16x16x32_bf16 v[84:87], a[76:79], a[200:203], v[84:87]
    ds_read_b128 a[220:223], v1 offset:16816
    v_and_b32 v227, s81, v65
    v_mfma_f32_16x16x32_bf16 v[92:95], a[76:79], a[204:207], v[92:95]
    v_lshlrev_b32 v228, 16, v66
    v_and_b32 v229, s81, v66
    s_waitcnt lgkmcnt(3)
    v_mfma_f32_16x16x32_bf16 v[80:83], a[80:83], a[208:211], v[80:83]
    ds_read_b128 a[224:227], v1 offset:192
    v_lshlrev_b32 v230, 16, v67
    v_and_b32 v231, s81, v67
    s_waitcnt lgkmcnt(3)
    v_mfma_f32_16x16x32_bf16 v[88:91], a[80:83], a[212:215], v[88:91]
    v_lshlrev_b32 v232, 16, v68
    v_and_b32 v233, s81, v68
    v_mfma_f32_16x16x32_bf16 v[84:87], a[84:87], a[208:211], v[84:87]
    ds_read_b128 a[228:231], v1 offset:16832
    v_lshlrev_b32 v234, 16, v69
    v_mfma_f32_16x16x32_bf16 v[92:95], a[84:87], a[212:215], v[92:95]
    v_and_b32 v235, s81, v69
    v_lshlrev_b32 v236, 16, v70
    s_waitcnt lgkmcnt(3)
    v_mfma_f32_16x16x32_bf16 v[80:83], a[88:91], a[216:219], v[80:83]
    ds_read_b128 a[232:235], v1 offset:208
    v_and_b32 v237, s81, v70
    s_waitcnt lgkmcnt(3)
    v_mfma_f32_16x16x32_bf16 v[88:91], a[88:91], a[220:223], v[88:91]
    v_lshlrev_b32 v238, 16, v71
    v_and_b32 v239, s81, v71
    v_mfma_f32_16x16x32_bf16 v[84:87], a[92:95], a[216:219], v[84:87]
    ds_read_b128 a[236:239], v1 offset:16848
    v_lshlrev_b32 v240, 16, v72
    v_mfma_f32_16x16x32_bf16 v[92:95], a[92:95], a[220:223], v[92:95]
    v_and_b32 v241, s81, v72
    v_lshlrev_b32 v242, 16, v73
    s_waitcnt lgkmcnt(3)
    v_mfma_f32_16x16x32_bf16 v[80:83], a[96:99], a[224:227], v[80:83]
    ds_read_b128 a[240:243], v1 offset:224
    v_and_b32 v243, s81, v73
    v_lshlrev_b32 v244, 16, v74
    s_waitcnt lgkmcnt(3)
    v_mfma_f32_16x16x32_bf16 v[88:91], a[96:99], a[228:231], v[88:91]
    v_and_b32 v245, s81, v74
    v_lshlrev_b32 v246, 16, v75
    v_mfma_f32_16x16x32_bf16 v[84:87], a[100:103], a[224:227], v[84:87]
    ds_read_b128 a[244:247], v1 offset:16864
    v_and_b32 v247, s81, v75
    v_mfma_f32_16x16x32_bf16 v[92:95], a[100:103], a[228:231], v[92:95]
    v_lshlrev_b32 v248, 16, v76
    v_and_b32 v249, s81, v76
    s_waitcnt lgkmcnt(3)
    v_mfma_f32_16x16x32_bf16 v[80:83], a[104:107], a[232:235], v[80:83]
    ds_read_b128 a[248:251], v1 offset:240
    v_lshlrev_b32 v250, 16, v77
    s_waitcnt lgkmcnt(3)
    v_mfma_f32_16x16x32_bf16 v[88:91], a[104:107], a[236:239], v[88:91]
    v_and_b32 v251, s81, v77
    v_lshlrev_b32 v252, 16, v78
    v_mfma_f32_16x16x32_bf16 v[84:87], a[108:111], a[232:235], v[84:87]
    ds_read_b128 a[252:255], v1 offset:16880
    v_and_b32 v253, s81, v78
    v_mfma_f32_16x16x32_bf16 v[92:95], a[108:111], a[236:239], v[92:95]
    v_lshlrev_b32 v254, 16, v79
    v_and_b32 v255, s81, v79
    s_waitcnt lgkmcnt(3)
    v_mfma_f32_16x16x32_bf16 v[80:83], a[112:115], a[240:243], v[80:83]
    ds_read_b128 a[192:195], v1 offset:33408
    s_waitcnt lgkmcnt(3)
    v_mfma_f32_16x16x32_bf16 v[88:91], a[112:115], a[244:247], v[88:91]
    v_mfma_f32_16x16x32_bf16 v[84:87], a[116:119], a[240:243], v[84:87]
    ds_read_b128 a[196:199], v1 offset:50048
    v_mfma_f32_16x16x32_bf16 v[92:95], a[116:119], a[244:247], v[92:95]
    s_waitcnt lgkmcnt(3)
    v_mfma_f32_16x16x32_bf16 v[80:83], a[120:123], a[248:251], v[80:83]
    ds_read_b128 a[200:203], v1 offset:33424
    s_waitcnt lgkmcnt(3)
    v_mfma_f32_16x16x32_bf16 v[88:91], a[120:123], a[252:255], v[88:91]
    v_mfma_f32_16x16x32_bf16 v[84:87], a[124:127], a[248:251], v[84:87]
    ds_read_b128 a[204:207], v1 offset:50064
    v_mfma_f32_16x16x32_bf16 v[92:95], a[124:127], a[252:255], v[92:95]
    s_waitcnt lgkmcnt(3)
    v_mfma_f32_16x16x32_bf16 v[112:115], a[64:67], a[192:195], v[112:115]
    s_waitcnt lgkmcnt(2)
    v_mfma_f32_16x16x32_bf16 v[120:123], a[64:67], a[196:199], v[120:123]
L_M2:
    ds_read_b128 a[208:211], v1 offset:33440
    buffer_load_dwordx4 a[64:67], v6, s[8:11], s21 offen offset:0
    v_mfma_f32_16x16x32_bf16 v[116:119], a[68:71], a[192:195], v[116:119]
    ds_read_b128 a[212:215], v1 offset:50080
    v_mfma_f32_16x16x32_bf16 v[124:127], a[68:71], a[196:199], v[124:127]
    buffer_load_dwordx4 a[68:71], v6, s[8:11], s21 offen offset:1024
    s_waitcnt lgkmcnt(3)
    v_mfma_f32_16x16x32_bf16 v[112:115], a[72:75], a[200:203], v[112:115]
    ds_read_b128 a[216:219], v1 offset:33456
    s_waitcnt lgkmcnt(3)
    v_mfma_f32_16x16x32_bf16 v[120:123], a[72:75], a[204:207], v[120:123]
    buffer_load_dwordx4 a[72:75], v6, s[8:11], s21 offen offset:2048
    v_cvt_pk_bf16_f32 v80, v80, v81
    v_cvt_pk_bf16_f32 v81, v82, v83
    v_cvt_pk_bf16_f32 v82, v84, v85
    v_cvt_pk_bf16_f32 v83, v86, v87
    v_mfma_f32_16x16x32_bf16 v[116:119], a[76:79], a[200:203], v[116:119]
    ds_read_b128 a[220:223], v1 offset:50096
    v_mfma_f32_16x16x32_bf16 v[124:127], a[76:79], a[204:207], v[124:127]
    buffer_load_dwordx4 a[76:79], v6, s[8:11], s21 offen offset:3072
    s_add_u32 s21, s21, 4096
    ds_write_b128 v4, v[80:83] offset:0
    v_cvt_pk_bf16_f32 v84, v88, v89
    v_cvt_pk_bf16_f32 v85, v90, v91
    v_cvt_pk_bf16_f32 v86, v92, v93
    v_cvt_pk_bf16_f32 v87, v94, v95
    s_waitcnt lgkmcnt(4)
    v_mfma_f32_16x16x32_bf16 v[112:115], a[80:83], a[208:211], v[112:115]
    s_waitcnt lgkmcnt(3)
    v_mfma_f32_16x16x32_bf16 v[120:123], a[80:83], a[212:215], v[120:123]
    buffer_load_dwordx4 a[80:83], v6, s[8:11], s21 offen offset:0
    v_mfma_f32_16x16x32_bf16 v[116:119], a[84:87], a[208:211], v[116:119]
    ds_read_b128 a[224:227], v1 offset:33472
    ds_read_b128 v[16:19], v5 offset:0
    ds_read_b128 a[228:231], v1 offset:50112
    v_mfma_f32_16x16x32_bf16 v[124:127], a[84:87], a[212:215], v[124:127]
    ds_read_b128 v[20:23], v5 offset:16
    buffer_load_dwordx4 a[84:87], v6, s[8:11], s21 offen offset:1024
    ds_write_b128 v4, v[84:87] offset:1280
    s_waitcnt lgkmcnt(7)
    v_mfma_f32_16x16x32_bf16 v[112:115], a[88:91], a[216:219], v[112:115]
    s_waitcnt lgkmcnt(6)
    v_mfma_f32_16x16x32_bf16 v[120:123], a[88:91], a[220:223], v[120:123]
    buffer_load_dwordx4 a[88:91], v6, s[8:11], s21 offen offset:2048
    v_mfma_f32_16x16x32_bf16 v[116:119], a[92:95], a[216:219], v[116:119]
    s_waitcnt lgkmcnt(0)
    s_barrier
    ds_read_b128 a[232:235], v1 offset:33488
    ds_read_b128 a[236:239], v1 offset:50128
    v_mfma_f32_16x16x32_bf16 v[124:127], a[92:95], a[220:223], v[124:127]
    buffer_load_dwordx4 a[92:95], v6, s[8:11], s21 offen offset:3072
    s_add_u32 s21, s21, 4096
    v_mfma_f32_16x16x32_bf16 v[112:115], a[96:99], a[224:227], v[112:115]
    ds_read_b128 a[240:243], v1 offset:33504
    ds_read_b128 a[128:131], v3 offset:0
    v_mfma_f32_16x16x32_bf16 v[120:123], a[96:99], a[228:231], v[120:123]
    ds_read_b128 a[132:135], v3 offset:1280
    v_mfma_f32_16x16x32_bf16 v[116:119], a[100:103], a[224:227], v[116:119]
    ds_read_b128 a[244:247], v1 offset:50144
    v_mfma_f32_16x16x32_bf16 v[124:127], a[100:103], a[228:231], v[124:127]
    ds_read_b128 a[136:139], v3 offset:16
    s_waitcnt lgkmcnt(6)
    v_mfma_f32_16x16x32_bf16 v[112:115], a[104:107], a[232:235], v[112:115]
    ds_read_b128 a[248:251], v1 offset:33520
    s_waitcnt lgkmcnt(6)
    v_mfma_f32_16x16x32_bf16 v[120:123], a[104:107], a[236:239], v[120:123]
    ds_read_b128 a[140:143], v3 offset:1296
    v_mfma_f32_16x16x32_bf16 v[116:119], a[108:111], a[232:235], v[116:119]
    ds_read_b128 a[252:255], v1 offset:50160
    v_mfma_f32_16x16x32_bf16 v[124:127], a[108:111], a[236:239], v[124:127]
    ds_read_b128 a[144:147], v3 offset:32
    s_waitcnt lgkmcnt(8)
    v_mfma_f32_16x16x32_bf16 v[112:115], a[112:115], a[240:243], v[112:115]
    ds_read_b128 a[148:151], v3 offset:1312
    s_waitcnt lgkmcnt(6)
    v_mfma_f32_16x16x32_bf16 v[120:123], a[112:115], a[244:247], v[120:123]
    v_mfma_f32_16x16x32_bf16 v[116:119], a[116:119], a[240:243], v[116:119]
    ds_read_b128 a[152:155], v3 offset:48
    v_mfma_f32_16x16x32_bf16 v[124:127], a[116:119], a[244:247], v[124:127]
    s_waitcnt lgkmcnt(5)
    v_mfma_f32_16x16x32_bf16 v[112:115], a[120:123], a[248:251], v[112:115]
    ds_read_b128 a[156:159], v3 offset:1328
    s_waitcnt lgkmcnt(4)
    v_mfma_f32_16x16x32_bf16 v[120:123], a[120:123], a[252:255], v[120:123]
    v_mfma_f32_16x16x32_bf16 v[116:119], a[124:127], a[248:251], v[116:119]
    v_mfma_f32_16x16x32_bf16 v[124:127], a[124:127], a[252:255], v[124:127]
    s_branch L_Ftop
L_Ftop:
    s_waitcnt vmcnt(20) lgkmcnt(7)
    v_mfma_f32_16x16x32_bf16 v[48:51], a[0:3], a[128:131], v[16:19]
    s_waitcnt lgkmcnt(6)
    v_mfma_f32_16x16x32_bf16 v[56:59], a[0:3], a[132:135], v[16:19]
L_F0:
    buffer_load_dwordx4 a[96:99], v6, s[8:11], s21 offen offset:0
    v_mfma_f32_16x16x32_bf16 v[52:55], a[4:7], a[128:131], v[20:23]
    v_mfma_f32_16x16x32_bf16 v[60:63], a[4:7], a[132:135], v[20:23]
    s_waitcnt lgkmcnt(5)
    v_mfma_f32_16x16x32_bf16 v[48:51], a[8:11], a[136:139], v[48:51]
    buffer_load_dwordx4 a[100:103], v6, s[8:11], s21 offen offset:1024
    v_cvt_pk_bf16_f32 v112, v112, v113
    v_cvt_pk_bf16_f32 v113, v114, v115
    s_waitcnt lgkmcnt(4)
    v_mfma_f32_16x16x32_bf16 v[56:59], a[8:11], a[140:143], v[56:59]
    v_cvt_pk_bf16_f32 v114, v116, v117
    v_cvt_pk_bf16_f32 v115, v118, v119
    v_mfma_f32_16x16x32_bf16 v[52:55], a[12:15], a[136:139], v[52:55]
    ds_write_b128 v4, v[112:115] offset:2560
    v_cvt_pk_bf16_f32 v116, v120, v121
    v_cvt_pk_bf16_f32 v117, v122, v123
    v_mfma_f32_16x16x32_bf16 v[60:63], a[12:15], a[140:143], v[60:63]
    v_cvt_pk_bf16_f32 v118, v124, v125
    v_cvt_pk_bf16_f32 v119, v126, v127
    s_waitcnt vmcnt(18) lgkmcnt(4)
    v_mfma_f32_16x16x32_bf16 v[48:51], a[16:19], a[144:147], v[48:51]
    buffer_load_dwordx4 a[104:107], v6, s[8:11], s21 offen offset:2048
    s_waitcnt lgkmcnt(3)
    v_mfma_f32_16x16x32_bf16 v[56:59], a[16:19], a[148:151], v[56:59]
    v_mfma_f32_16x16x32_bf16 v[52:55], a[20:23], a[144:147], v[52:55]
    ds_read_b128 v[24:27], v5 offset:128
    ds_read_b128 v[28:31], v5 offset:144
    v_mfma_f32_16x16x32_bf16 v[60:63], a[20:23], a[148:151], v[60:63]
    ds_write_b128 v4, v[116:119] offset:3840
    s_waitcnt lgkmcnt(5)
    v_mfma_f32_16x16x32_bf16 v[48:51], a[24:27], a[152:155], v[48:51]
    buffer_load_dwordx4 a[108:111], v6, s[8:11], s21 offen offset:3072
    s_waitcnt lgkmcnt(4)
    v_mfma_f32_16x16x32_bf16 v[56:59], a[24:27], a[156:159], v[56:59]
    s_add_u32 s21, s21, 4096
    v_mfma_f32_16x16x32_bf16 v[52:55], a[28:31], a[152:155], v[52:55]
    s_waitcnt lgkmcnt(0)
    s_barrier
    ds_read_b128 v[32:35], v2 offset:0
    v_mfma_f32_16x16x32_bf16 v[60:63], a[28:31], a[156:159], v[60:63]
    ds_read_b128 v[36:39], v2 offset:16640
    s_waitcnt vmcnt(16)
    v_mfma_f32_16x16x32_bf16 v[64:67], a[32:35], a[128:131], v[24:27]
    ds_read_b128 a[160:163], v3 offset:2560
    ds_read_b128 a[164:167], v3 offset:3840
    v_mfma_f32_16x16x32_bf16 v[72:75], a[32:35], a[132:135], v[24:27]
    buffer_load_dwordx4 a[112:115], v6, s[8:11], s21 offen offset:0
    v_mfma_f32_16x16x32_bf16 v[68:71], a[36:39], a[128:131], v[28:31]
    ds_read_b128 a[168:171], v3 offset:2576
    v_mfma_f32_16x16x32_bf16 v[76:79], a[36:39], a[132:135], v[28:31]
    v_mfma_f32_16x16x32_bf16 v[64:67], a[40:43], a[136:139], v[64:67]
    ds_read_b128 a[172:175], v3 offset:3856
    buffer_load_dwordx4 a[116:119], v6, s[8:11], s21 offen offset:1024
    s_waitcnt lgkmcnt(5)
    v_lshlrev_b32 v8, 16, v32
    v_and_b32 v9, s81, v32
    v_mfma_f32_16x16x32_bf16 v[72:75], a[40:43], a[140:143], v[72:75]
    v_lshlrev_b32 v10, 16, v33
    v_and_b32 v11, s81, v33
    v_fmac_f32 v8, v128, v48
    v_mfma_f32_16x16x32_bf16 v[68:71], a[44:47], a[136:139], v[68:71]
    ds_read_b128 a[176:179], v3 offset:2592
    ds_read_b128 a[180:183], v3 offset:3872
    v_fmac_f32 v9, v129, v49
    v_mfma_f32_16x16x32_bf16 v[76:79], a[44:47], a[140:143], v[76:79]
    v_fmac_f32 v10, v130, v50
    v_fmac_f32 v11, v131, v51
    v_cvt_pk_bf16_f32 v32, v8, v9
    s_waitcnt vmcnt(14)
    v_mfma_f32_16x16x32_bf16 v[64:67], a[48:51], a[144:147], v[64:67]
    ds_read_b128 a[184:187], v3 offset:2608
    buffer_load_dwordx4 a[120:123], v6, s[8:11], s21 offen offset:2048
    v_cvt_pk_bf16_f32 v33, v10, v11
    v_lshlrev_b32 v8, 16, v34
    v_mfma_f32_16x16x32_bf16 v[72:75], a[48:51], a[148:151], v[72:75]
    v_and_b32 v9, s81, v34
    v_lshlrev_b32 v10, 16, v35
    v_and_b32 v11, s81, v35
    v_mfma_f32_16x16x32_bf16 v[68:71], a[52:55], a[144:147], v[68:71]
    ds_read_b128 a[188:191], v3 offset:3888
    v_fmac_f32 v8, v132, v52
    v_fmac_f32 v9, v133, v53
    v_mfma_f32_16x16x32_bf16 v[76:79], a[52:55], a[148:151], v[76:79]
    v_fmac_f32 v10, v134, v54
    v_fmac_f32 v11, v135, v55
    v_cvt_pk_bf16_f32 v34, v8, v9
    v_mfma_f32_16x16x32_bf16 v[64:67], a[56:59], a[152:155], v[64:67]
    buffer_load_dwordx4 a[124:127], v6, s[8:11], s21 offen offset:3072
    s_add_u32 s21, s21, 4096
    v_cvt_pk_bf16_f32 v35, v10, v11
    v_mfma_f32_16x16x32_bf16 v[72:75], a[56:59], a[156:159], v[72:75]
    s_waitcnt lgkmcnt(8)
    v_lshlrev_b32 v8, 16, v36
    v_and_b32 v9, s81, v36
    v_mfma_f32_16x16x32_bf16 v[68:71], a[60:63], a[152:155], v[68:71]
    ds_read_b128 v[40:43], v2 offset:64
    ds_write_b128 v2, v[32:35] offset:0
    v_lshlrev_b32 v10, 16, v37
    v_and_b32 v11, s81, v37
    v_mfma_f32_16x16x32_bf16 v[76:79], a[60:63], a[156:159], v[76:79]
    v_fmac_f32 v8, v136, v56
    v_fmac_f32 v9, v137, v57
    v_fmac_f32 v10, v138, v58
    s_waitcnt lgkmcnt(9)
    v_mfma_f32_16x16x32_bf16 v[80:83], a[0:3], a[160:163], v[16:19]
    s_waitcnt lgkmcnt(8)
    v_mfma_f32_16x16x32_bf16 v[88:91], a[0:3], a[164:167], v[16:19]
L_F1:
    buffer_load_dwordx4 a[0:3], v6, s[8:11], s21 offen offset:0
    v_fmac_f32 v11, v139, v59
    v_cvt_pk_bf16_f32 v36, v8, v9
    v_cvt_pk_bf16_f32 v37, v10, v11
    v_lshlrev_b32 v8, 16, v38
    v_and_b32 v9, s81, v38
    v_mfma_f32_16x16x32_bf16 v[84:87], a[4:7], a[160:163], v[20:23]
    ds_read_b128 v[44:47], v2 offset:16704
    v_lshlrev_b32 v10, 16, v39
    v_and_b32 v11, s81, v39
    v_mfma_f32_16x16x32_bf16 v[92:95], a[4:7], a[164:167], v[20:23]
    v_fmac_f32 v8, v140, v60
    v_fmac_f32 v9, v141, v61
    s_waitcnt lgkmcnt(8)
    v_mfma_f32_16x16x32_bf16 v[80:83], a[8:11], a[168:171], v[80:83]
    buffer_load_dwordx4 a[4:7], v6, s[8:11], s21 offen offset:1024
    v_fmac_f32 v10, v142, v62
    v_fmac_f32 v11, v143, v63
    s_waitcnt lgkmcnt(7)
    v_mfma_f32_16x16x32_bf16 v[88:91], a[8:11], a[172:175], v[88:91]
    v_cvt_pk_bf16_f32 v38, v8, v9
    v_cvt_pk_bf16_f32 v39, v10, v11
    v_mfma_f32_16x16x32_bf16 v[84:87], a[12:15], a[168:171], v[84:87]
    ds_read_b128 v[16:19], v5 offset:256
    ds_write_b128 v2, v[36:39] offset:16640
    s_waitcnt lgkmcnt(4)
    v_lshlrev_b32 v8, 16, v40
    v_and_b32 v9, s81, v40
    v_mfma_f32_16x16x32_bf16 v[92:95], a[12:15], a[172:175], v[92:95]
    v_lshlrev_b32 v10, 16, v41
    v_and_b32 v11, s81, v41
    v_fmac_f32 v8, v160, v64
    v_mfma_f32_16x16x32_bf16 v[80:83], a[16:19], a[176:179], v[80:83]
    buffer_load_dwordx4 a[8:11], v6, s[8:11], s21 offen offset:2048
    v_fmac_f32 v9, v161, v65
    v_fmac_f32 v10, v162, v66
    v_mfma_f32_16x16x32_bf16 v[88:91], a[16:19], a[180:183], v[88:91]
    v_fmac_f32 v11, v163, v67
    v_cvt_pk_bf16_f32 v40, v8, v9
    v_mfma_f32_16x16x32_bf16 v[84:87], a[20:23], a[176:179], v[84:87]
    ds_read_b128 v[20:23], v5 offset:272
    v_cvt_pk_bf16_f32 v41, v10, v11
    v_lshlrev_b32 v8, 16, v42
    v_mfma_f32_16x16x32_bf16 v[92:95], a[20:23], a[180:183], v[92:95]
    v_and_b32 v9, s81, v42
    v_lshlrev_b32 v10, 16, v43
    v_and_b32 v11, s81, v43
    v_mfma_f32_16x16x32_bf16 v[80:83], a[24:27], a[184:187], v[80:83]
    buffer_load_dwordx4 a[12:15], v6, s[8:11], s21 offen offset:3072
    s_add_u32 s21, s21, 4096
    v_fmac_f32 v8, v164, v68
    v_fmac_f32 v9, v165, v69
    v_mfma_f32_16x16x32_bf16 v[88:91], a[24:27], a[188:191], v[88:91]
    v_fmac_f32 v10, v166, v70
    v_fmac_f32 v11, v167, v71
    v_cvt_pk_bf16_f32 v42, v8, v9
    v_mfma_f32_16x16x32_bf16 v[84:87], a[28:31], a[184:187], v[84:87]
    v_cvt_pk_bf16_f32 v43, v10, v11
    s_waitcnt lgkmcnt(3)
    v_lshlrev_b32 v8, 16, v44
    v_mfma_f32_16x16x32_bf16 v[92:95], a[28:31], a[188:191], v[92:95]
    v_and_b32 v9, s81, v44
    v_mfma_f32_16x16x32_bf16 v[48:51], a[32:35], a[160:163], v[24:27]
    ds_read_b128 v[32:35], v2 offset:33280
    buffer_load_dwordx4 a[16:19], v6, s[8:11], s21 offen offset:0
    ds_write_b128 v2, v[40:43] offset:64
    v_lshlrev_b32 v10, 16, v45
    v_mfma_f32_16x16x32_bf16 v[56:59], a[32:35], a[164:167], v[24:27]
    v_and_b32 v11, s81, v45
    v_fmac_f32 v8, v168, v72
    v_fmac_f32 v9, v169, v73
    v_fmac_f32 v10, v170, v74
    v_mfma_f32_16x16x32_bf16 v[52:55], a[36:39], a[160:163], v[28:31]
    v_fmac_f32 v11, v171, v75
    v_cvt_pk_bf16_f32 v44, v8, v9
    v_cvt_pk_bf16_f32 v45, v10, v11
    v_mfma_f32_16x16x32_bf16 v[60:63], a[36:39], a[164:167], v[28:31]
    v_lshlrev_b32 v8, 16, v46
    v_and_b32 v9, s81, v46
    v_mfma_f32_16x16x32_bf16 v[48:51], a[40:43], a[168:171], v[48:51]
    ds_read_b128 v[36:39], v2 offset:49920
    buffer_load_dwordx4 a[20:23], v6, s[8:11], s21 offen offset:1024
    v_lshlrev_b32 v10, 16, v47
    v_mfma_f32_16x16x32_bf16 v[56:59], a[40:43], a[172:175], v[56:59]
    v_and_b32 v11, s81, v47
    v_fmac_f32 v8, v172, v76
    v_fmac_f32 v9, v173, v77
    v_mfma_f32_16x16x32_bf16 v[52:55], a[44:47], a[168:171], v[52:55]
    v_fmac_f32 v10, v174, v78
    v_fmac_f32 v11, v175, v79
    v_mfma_f32_16x16x32_bf16 v[60:63], a[44:47], a[172:175], v[60:63]
    v_cvt_pk_bf16_f32 v46, v8, v9
    v_cvt_pk_bf16_f32 v47, v10, v11
    v_mfma_f32_16x16x32_bf16 v[48:51], a[48:51], a[176:179], v[48:51]
    buffer_load_dwordx4 a[24:27], v6, s[8:11], s21 offen offset:2048
    ds_write_b128 v2, v[44:47] offset:16704
    s_waitcnt lgkmcnt(3)
    v_lshlrev_b32 v8, 16, v32
    v_mfma_f32_16x16x32_bf16 v[56:59], a[48:51], a[180:183], v[56:59]
    v_and_b32 v9, s81, v32
    v_lshlrev_b32 v10, 16, v33
    v_and_b32 v11, s81, v33
    v_mfma_f32_16x16x32_bf16 v[52:55], a[52:55], a[176:179], v[52:55]
    v_fmac_f32 v8, v144, v80
    v_fmac_f32 v9, v145, v81
    v_mfma_f32_16x16x32_bf16 v[60:63], a[52:55], a[180:183], v[60:63]
    v_fmac_f32 v10, v146, v82
    v_fmac_f32 v11, v147, v83
    v_mfma_f32_16x16x32_bf16 v[48:51], a[56:59], a[184:187], v[48:51]
    buffer_load_dwordx4 a[28:31], v6, s[8:11], s21 offen offset:3072
    s_add_u32 s21, s21, 4096
    v_cvt_pk_bf16_f32 v32, v8, v9
    v_cvt_pk_bf16_f32 v33, v10, v11
    v_mfma_f32_16x16x32_bf16 v[56:59], a[56:59], a[188:191], v[56:59]
    v_lshlrev_b32 v8, 16, v34
    v_and_b32 v9, s81, v34
    v_lshlrev_b32 v10, 16, v35
    v_mfma_f32_16x16x32_bf16 v[52:55], a[60:63], a[184:187], v[52:55]
    v_and_b32 v11, s81, v35
    v_fmac_f32 v8, v148, v84
    v_mfma_f32_16x16x32_bf16 v[60:63], a[60:63], a[188:191], v[60:63]
    v_fmac_f32 v9, v149, v85
    v_fmac_f32 v10, v150, v86
    s_waitcnt vmcnt(20)
    v_mfma_f32_16x16x32_bf16 v[96:99], a[64:67], a[128:131], v[16:19]
    v_mfma_f32_16x16x32_bf16 v[104:107], a[64:67], a[132:135], v[16:19]
L_F2:
    buffer_load_dwordx4 a[32:35], v6, s[8:11], s21 offen offset:0
    v_fmac_f32 v11, v151, v87
    v_cvt_pk_bf16_f32 v34, v8, v9
    v_cvt_pk_bf16_f32 v35, v10, v11
    v_mfma_f32_16x16x32_bf16 v[100:103], a[68:71], a[128:131], v[20:23]
    ds_write_b128 v2, v[32:35] offset:33280
    s_waitcnt lgkmcnt(2)
    v_lshlrev_b32 v8, 16, v36
    v_and_b32 v9, s81, v36
    v_mfma_f32_16x16x32_bf16 v[108:111], a[68:71], a[132:135], v[20:23]
    v_lshlrev_b32 v10, 16, v37
    v_and_b32 v11, s81, v37
    v_mfma_f32_16x16x32_bf16 v[96:99], a[72:75], a[136:139], v[96:99]
    buffer_load_dwordx4 a[36:39], v6, s[8:11], s21 offen offset:1024
    v_fmac_f32 v8, v152, v88
    v_fmac_f32 v9, v153, v89
    v_mfma_f32_16x16x32_bf16 v[104:107], a[72:75], a[140:143], v[104:107]
    v_fmac_f32 v10, v154, v90
    v_fmac_f32 v11, v155, v91
    v_mfma_f32_16x16x32_bf16 v[100:103], a[76:79], a[136:139], v[100:103]
    ds_read_b128 v[40:43], v2 offset:33344
    ds_read_b128 v[44:47], v2 offset:49984
    v_cvt_pk_bf16_f32 v36, v8, v9
    v_cvt_pk_bf16_f32 v37, v10, v11
    v_mfma_f32_16x16x32_bf16 v[108:111], a[76:79], a[140:143], v[108:111]
    v_lshlrev_b32 v8, 16, v38
    v_and_b32 v9, s81, v38
    v_lshlrev_b32 v10, 16, v39
    s_waitcnt vmcnt(18)
    v_mfma_f32_16x16x32_bf16 v[96:99], a[80:83], a[144:147], v[96:99]
    buffer_load_dwordx4 a[40:43], v6, s[8:11], s21 offen offset:2048
    v_and_b32 v11, s81, v39
    v_fmac_f32 v8, v156, v92
    v_mfma_f32_16x16x32_bf16 v[104:107], a[80:83], a[148:151], v[104:107]
    v_fmac_f32 v9, v157, v93
    v_fmac_f32 v10, v158, v94
    v_mfma_f32_16x16x32_bf16 v[100:103], a[84:87], a[144:147], v[100:103]
    v_fmac_f32 v11, v159, v95
    v_cvt_pk_bf16_f32 v38, v8, v9
    v_mfma_f32_16x16x32_bf16 v[108:111], a[84:87], a[148:151], v[108:111]
    v_cvt_pk_bf16_f32 v39, v10, v11
    v_mfma_f32_16x16x32_bf16 v[96:99], a[88:91], a[152:155], v[96:99]
    buffer_load_dwordx4 a[44:47], v6, s[8:11], s21 offen offset:3072
    s_add_u32 s21, s21, 4096
    ds_write_b128 v2, v[36:39] offset:49920
    s_waitcnt lgkmcnt(2)
    v_lshlrev_b32 v8, 16, v40
    v_mfma_f32_16x16x32_bf16 v[104:107], a[88:91], a[156:159], v[104:107]
    v_and_b32 v9, s81, v40
    v_lshlrev_b32 v10, 16, v41
    v_and_b32 v11, s81, v41
    v_mfma_f32_16x16x32_bf16 v[100:103], a[92:95], a[152:155], v[100:103]
    v_fmac_f32 v8, v176, v48
    v_fmac_f32 v9, v177, v49
    v_mfma_f32_16x16x32_bf16 v[108:111], a[92:95], a[156:159], v[108:111]
    v_fmac_f32 v10, v178, v50
    v_fmac_f32 v11, v179, v51
    v_mfma_f32_16x16x32_bf16 v[64:67], a[64:67], a[160:163], v[16:19]
    buffer_load_dwordx4 a[48:51], v6, s[8:11], s21 offen offset:0
    v_cvt_pk_bf16_f32 v40, v8, v9
    v_mfma_f32_16x16x32_bf16 v[72:75], a[64:67], a[164:167], v[16:19]
    v_cvt_pk_bf16_f32 v41, v10, v11
    v_lshlrev_b32 v8, 16, v42
    v_mfma_f32_16x16x32_bf16 v[68:71], a[68:71], a[160:163], v[20:23]
    v_and_b32 v9, s81, v42
    v_lshlrev_b32 v10, 16, v43
    v_mfma_f32_16x16x32_bf16 v[76:79], a[68:71], a[164:167], v[20:23]
    v_and_b32 v11, s81, v43
    v_fmac_f32 v8, v180, v52
    v_mfma_f32_16x16x32_bf16 v[64:67], a[72:75], a[168:171], v[64:67]
    s_waitcnt lgkmcnt(0)
    s_barrier
    ds_read_b128 a[192:195], v1 offset:0
    ds_read_b128 a[196:199], v1 offset:16640
    ds_read_b128 a[200:203], v1 offset:16
    ds_read_b128 a[204:207], v1 offset:16656
    v_mfma_f32_16x16x32_bf16 v[72:75], a[72:75], a[172:175], v[72:75]
    buffer_load_dwordx4 a[52:55], v6, s[8:11], s21 offen offset:1024
    v_fmac_f32 v9, v181, v53
    v_fmac_f32 v10, v182, v54
    v_fmac_f32 v11, v183, v55
    v_cvt_pk_bf16_f32 v42, v8, v9
    v_mfma_f32_16x16x32_bf16 v[68:71], a[76:79], a[168:171], v[68:71]
    v_cvt_pk_bf16_f32 v43, v10, v11
    v_lshlrev_b32 v8, 16, v44
    v_mfma_f32_16x16x32_bf16 v[76:79], a[76:79], a[172:175], v[76:79]
    v_and_b32 v9, s81, v44
    v_mfma_f32_16x16x32_bf16 v[64:67], a[80:83], a[176:179], v[64:67]
    ds_read_b128 a[208:211], v1 offset:32
    ds_read_b128 a[212:215], v1 offset:16672
    buffer_load_dwordx4 a[56:59], v6, s[8:11], s21 offen offset:2048
    ds_write_b128 v2, v[40:43] offset:33344
    v_mfma_f32_16x16x32_bf16 v[72:75], a[80:83], a[180:183], v[72:75]
    v_lshlrev_b32 v10, 16, v45
    v_and_b32 v11, s81, v45
    v_fmac_f32 v8, v184, v56
    v_fmac_f32 v9, v185, v57
    v_mfma_f32_16x16x32_bf16 v[68:71], a[84:87], a[176:179], v[68:71]
    v_fmac_f32 v10, v186, v58
    v_fmac_f32 v11, v187, v59
    v_mfma_f32_16x16x32_bf16 v[76:79], a[84:87], a[180:183], v[76:79]
    v_cvt_pk_bf16_f32 v44, v8, v9
    v_cvt_pk_bf16_f32 v45, v10, v11
    v_mfma_f32_16x16x32_bf16 v[64:67], a[88:91], a[184:187], v[64:67]
    ds_read_b128 v[32:35], v2 offset:128
    ds_read_b128 a[216:219], v1 offset:48
    ds_read_b128 a[220:223], v1 offset:16688
    buffer_load_dwordx4 a[60:63], v6, s[8:11], s21 offen offset:3072
    v_mfma_f32_16x16x32_bf16 v[72:75], a[88:91], a[188:191], v[72:75]
    s_add_u32 s21, s21, 4096
    v_lshlrev_b32 v8, 16, v46
    v_and_b32 v9, s81, v46
    v_lshlrev_b32 v10, 16, v47
    v_mfma_f32_16x16x32_bf16 v[68:71], a[92:95], a[184:187], v[68:71]
    ds_read_b128 v[36:39], v2 offset:16768
    v_and_b32 v11, s81, v47
    v_fmac_f32 v8, v188, v60
    v_mfma_f32_16x16x32_bf16 v[76:79], a[92:95], a[188:191], v[76:79]
    v_fmac_f32 v9, v189, v61
    v_fmac_f32 v10, v190, v62
    s_waitcnt vmcnt(20) lgkmcnt(7)
    v_mfma_f32_16x16x32_bf16 v[80:83], a[96:99], a[192:195], 0
    v_mfma_f32_16x16x32_bf16 v[88:91], a[96:99], a[196:199], 0
L_F3:
    ds_read_b128 a[224:227], v1 offset:33280
    ds_read_b128 a[228:231], v1 offset:49920
    buffer_load_dwordx4 a[64:67], v6, s[8:11], s21 offen offset:0
    v_fmac_f32 v11, v191, v63
    v_cvt_pk_bf16_f32 v46, v8, v9
    v_mfma_f32_16x16x32_bf16 v[84:87], a[100:103], a[192:195], 0
    v_cvt_pk_bf16_f32 v47, v10, v11
    v_mfma_f32_16x16x32_bf16 v[92:95], a[100:103], a[196:199], 0
    v_mfma_f32_16x16x32_bf16 v[80:83], a[104:107], a[200:203], v[80:83]
    ds_read_b128 v[16:19], v5 offset:384
    ds_read_b128 a[232:235], v1 offset:33296
    ds_read_b128 a[236:239], v1 offset:49936
    buffer_load_dwordx4 a[68:71], v6, s[8:11], s21 offen offset:1024
    v_mfma_f32_16x16x32_bf16 v[88:91], a[104:107], a[204:207], v[88:91]
    ds_write_b128 v2, v[44:47] offset:49984
    s_waitcnt lgkmcnt(9)
    v_lshlrev_b32 v8, 16, v32
    v_and_b32 v9, s81, v32
    v_mfma_f32_16x16x32_bf16 v[84:87], a[108:111], a[200:203], v[84:87]
    v_lshlrev_b32 v10, 16, v33
    v_and_b32 v11, s81, v33
    v_mfma_f32_16x16x32_bf16 v[92:95], a[108:111], a[204:207], v[92:95]
    v_fmac_f32 v8, v192, v96
    s_waitcnt vmcnt(18) lgkmcnt(7)
    v_mfma_f32_16x16x32_bf16 v[80:83], a[112:115], a[208:211], v[80:83]
    ds_read_b128 a[240:243], v1 offset:33312
    ds_read_b128 a[244:247], v1 offset:49952
    buffer_load_dwordx4 a[72:75], v6, s[8:11], s21 offen offset:2048
    v_mfma_f32_16x16x32_bf16 v[88:91], a[112:115], a[212:215], v[88:91]
    v_fmac_f32 v9, v193, v97
    v_fmac_f32 v10, v194, v98
    v_mfma_f32_16x16x32_bf16 v[84:87], a[116:119], a[208:211], v[84:87]
    ds_read_b128 v[20:23], v5 offset:400
    v_fmac_f32 v11, v195, v99
    v_mfma_f32_16x16x32_bf16 v[92:95], a[116:119], a[212:215], v[92:95]
    v_cvt_pk_bf16_f32 v32, v8, v9
    v_mfma_f32_16x16x32_bf16 v[80:83], a[120:123], a[216:219], v[80:83]
    ds_read_b128 a[248:251], v1 offset:33328
    ds_read_b128 a[252:255], v1 offset:49968
    buffer_load_dwordx4 a[76:79], v6, s[8:11], s21 offen offset:3072
    s_add_u32 s21, s21, 4096
    v_mfma_f32_16x16x32_bf16 v[88:91], a[120:123], a[220:223], v[88:91]
    v_cvt_pk_bf16_f32 v33, v10, v11
    v_lshlrev_b32 v8, 16, v34
    v_and_b32 v9, s81, v34
    v_mfma_f32_16x16x32_bf16 v[84:87], a[124:127], a[216:219], v[84:87]
    v_lshlrev_b32 v10, 16, v35
    v_mfma_f32_16x16x32_bf16 v[92:95], a[124:127], a[220:223], v[92:95]
    v_and_b32 v11, s81, v35
    s_waitcnt lgkmcnt(6)
    v_mfma_f32_16x16x32_bf16 v[112:115], a[96:99], a[224:227], 0
    buffer_load_dwordx4 a[80:83], v6, s[8:11], s21 offen offset:0
    v_fmac_f32 v8, v196, v100
    v_mfma_f32_16x16x32_bf16 v[120:123], a[96:99], a[228:231], 0
    v_fmac_f32 v9, v197, v101
    v_mfma_f32_16x16x32_bf16 v[116:119], a[100:103], a[224:227], 0
    v_fmac_f32 v10, v198, v102
    v_fmac_f32 v11, v199, v103
    v_mfma_f32_16x16x32_bf16 v[124:127], a[100:103], a[228:231], 0
    v_cvt_pk_bf16_f32 v34, v8, v9
    v_mfma_f32_16x16x32_bf16 v[112:115], a[104:107], a[232:235], v[112:115]
    buffer_load_dwordx4 a[84:87], v6, s[8:11], s21 offen offset:1024
    v_mfma_f32_16x16x32_bf16 v[120:123], a[104:107], a[236:239], v[120:123]
    v_cvt_pk_bf16_f32 v35, v10, v11
    v_mfma_f32_16x16x32_bf16 v[116:119], a[108:111], a[232:235], v[116:119]
    ds_write_b128 v2, v[32:35] offset:128
    v_lshlrev_b32 v8, 16, v36
    v_mfma_f32_16x16x32_bf16 v[124:127], a[108:111], a[236:239], v[124:127]
    v_and_b32 v9, s81, v36
    s_waitcnt lgkmcnt(1)
    v_mfma_f32_16x16x32_bf16 v[112:115], a[112:115], a[240:243], v[112:115]
    buffer_load_dwordx4 a[88:91], v6, s[8:11], s21 offen offset:2048
    v_lshlrev_b32 v10, 16, v37
    v_mfma_f32_16x16x32_bf16 v[120:123], a[112:115], a[244:247], v[120:123]
    v_and_b32 v11, s81, v37
    v_fmac_f32 v8, v200, v104
    v_mfma_f32_16x16x32_bf16 v[116:119], a[116:119], a[240:243], v[116:119]
    v_fmac_f32 v9, v201, v105
    v_mfma_f32_16x16x32_bf16 v[124:127], a[116:119], a[244:247], v[124:127]
    v_fmac_f32 v10, v202, v106
    v_mfma_f32_16x16x32_bf16 v[112:115], a[120:123], a[248:251], v[112:115]
    ds_read_b128 v[40:43], v2 offset:33408
    buffer_load_dwordx4 a[92:95], v6, s[8:11], s21 offen offset:3072
    s_add_u32 s21, s21, 4096
    v_mfma_f32_16x16x32_bf16 v[120:123], a[120:123], a[252:255], v[120:123]
    v_fmac_f32 v11, v203, v107
    v_cvt_pk_bf16_f32 v36, v8, v9
    v_mfma_f32_16x16x32_bf16 v[116:119], a[124:127], a[248:251], v[116:119]
    ds_read_b128 v[44:47], v2 offset:50048
    v_cvt_pk_bf16_f32 v37, v10, v11
    v_mfma_f32_16x16x32_bf16 v[124:127], a[124:127], a[252:255], v[124:127]
    v_lshlrev_b32 v8, 16, v38
    v_and_b32 v9, s81, v38
    s_waitcnt vmcnt(20)
    v_mfma_f32_16x16x32_bf16 v[48:51], a[0:3], a[128:131], v[16:19]
    v_mfma_f32_16x16x32_bf16 v[56:59], a[0:3], a[132:135], v[16:19]
L_F4:
    buffer_load_dwordx4 a[96:99], v6, s[8:11], s21 offen offset:0
    v_lshlrev_b32 v10, 16, v39
    v_and_b32 v11, s81, v39
    v_fmac_f32 v8, v204, v108
    v_fmac_f32 v9, v205, v109
    v_mfma_f32_16x16x32_bf16 v[52:55], a[4:7], a[128:131], v[20:23]
    v_fmac_f32 v10, v206, v110
    v_fmac_f32 v11, v207, v111
    v_mfma_f32_16x16x32_bf16 v[60:63], a[4:7], a[132:135], v[20:23]
    v_cvt_pk_bf16_f32 v38, v8, v9
    v_cvt_pk_bf16_f32 v39, v10, v11
    v_mfma_f32_16x16x32_bf16 v[48:51], a[8:11], a[136:139], v[48:51]
    buffer_load_dwordx4 a[100:103], v6, s[8:11], s21 offen offset:1024
    ds_write_b128 v2, v[36:39] offset:16768
    s_waitcnt lgkmcnt(2)
    v_lshlrev_b32 v8, 16, v40
    v_mfma_f32_16x16x32_bf16 v[56:59], a[8:11], a[140:143], v[56:59]
    v_and_b32 v9, s81, v40
    v_lshlrev_b32 v10, 16, v41
    v_mfma_f32_16x16x32_bf16 v[52:55], a[12:15], a[136:139], v[52:55]
    v_and_b32 v11, s81, v41
    v_fmac_f32 v8, v208, v64
    v_mfma_f32_16x16x32_bf16 v[60:63], a[12:15], a[140:143], v[60:63]
    v_fmac_f32 v9, v209, v65
    s_waitcnt vmcnt(18)
    v_mfma_f32_16x16x32_bf16 v[48:51], a[16:19], a[144:147], v[48:51]
    buffer_load_dwordx4 a[104:107], v6, s[8:11], s21 offen offset:2048
    v_fmac_f32 v10, v210, v66
    v_mfma_f32_16x16x32_bf16 v[56:59], a[16:19], a[148:151], v[56:59]
    v_fmac_f32 v11, v211, v67
    v_cvt_pk_bf16_f32 v40, v8, v9
    v_mfma_f32_16x16x32_bf16 v[52:55], a[20:23], a[144:147], v[52:55]
    v_cvt_pk_bf16_f32 v41, v10, v11
    v_lshlrev_b32 v8, 16, v42
    v_mfma_f32_16x16x32_bf16 v[60:63], a[20:23], a[148:151], v[60:63]
    v_and_b32 v9, s81, v42
    v_mfma_f32_16x16x32_bf16 v[48:51], a[24:27], a[152:155], v[48:51]
    s_waitcnt lgkmcnt(0)
    s_barrier
    buffer_load_dwordx4 a[108:111], v6, s[8:11], s21 offen offset:3072
    s_add_u32 s21, s21, 4096
    v_mfma_f32_16x16x32_bf16 v[56:59], a[24:27], a[156:159], v[56:59]
    v_lshlrev_b32 v10, 16, v43
    v_and_b32 v11, s81, v43
    v_fmac_f32 v8, v212, v68
    v_mfma_f32_16x16x32_bf16 v[52:55], a[28:31], a[152:155], v[52:55]
    v_fmac_f32 v9, v213, v69
    v_fmac_f32 v10, v214, v70
    v_mfma_f32_16x16x32_bf16 v[60:63], a[28:31], a[156:159], v[60:63]
    v_fmac_f32 v11, v215, v71
    v_mfma_f32_16x16x32_bf16 v[96:99], a[0:3], a[160:163], v[16:19]
    buffer_load_dwordx4 a[112:115], v6, s[8:11], s21 offen offset:0
    v_cvt_pk_bf16_f32 v42, v8, v9
    v_mfma_f32_16x16x32_bf16 v[104:107], a[0:3], a[164:167], v[16:19]
    v_cvt_pk_bf16_f32 v43, v10, v11
    v_mfma_f32_16x16x32_bf16 v[100:103], a[4:7], a[160:163], v[20:23]
    ds_read_b128 a[192:195], v1 offset:64
    ds_read_b128 a[196:199], v1 offset:16704
    ds_write_b128 v2, v[40:43] offset:33408
    v_mfma_f32_16x16x32_bf16 v[108:111], a[4:7], a[164:167], v[20:23]
    v_lshlrev_b32 v8, 16, v44
    v_and_b32 v9, s81, v44
    v_lshlrev_b32 v10, 16, v45
    v_mfma_f32_16x16x32_bf16 v[96:99], a[8:11], a[168:171], v[96:99]
    buffer_load_dwordx4 a[116:119], v6, s[8:11], s21 offen offset:1024
    v_add_u32 v5, 2048, v5
    v_and_b32 v11, s81, v45
    v_mfma_f32_16x16x32_bf16 v[104:107], a[8:11], a[172:175], v[104:107]
    v_fmac_f32 v8, v216, v72
    v_fmac_f32 v9, v217, v73
    v_mfma_f32_16x16x32_bf16 v[100:103], a[12:15], a[168:171], v[100:103]
    ds_read_b128 a[200:203], v1 offset:80
    ds_read_b128 a[204:207], v1 offset:16720
    v_fmac_f32 v10, v218, v74
    v_mfma_f32_16x16x32_bf16 v[108:111], a[12:15], a[172:175], v[108:111]
    v_fmac_f32 v11, v219, v75
    v_cvt_pk_bf16_f32 v44, v8, v9
    v_mfma_f32_16x16x32_bf16 v[96:99], a[16:19], a[176:179], v[96:99]
    ds_read_b128 v[32:35], v2 offset:192
    ds_read_b128 a[208:211], v1 offset:96
    ds_read_b128 a[212:215], v1 offset:16736
    buffer_load_dwordx4 a[120:123], v6, s[8:11], s21 offen offset:2048
    v_mfma_f32_16x16x32_bf16 v[104:107], a[16:19], a[180:183], v[104:107]
    v_cvt_pk_bf16_f32 v45, v10, v11
    v_lshlrev_b32 v8, 16, v46
    v_and_b32 v9, s81, v46
    v_mfma_f32_16x16x32_bf16 v[100:103], a[20:23], a[176:179], v[100:103]
    ds_read_b128 v[36:39], v2 offset:16832
    v_lshlrev_b32 v10, 16, v47
    v_mfma_f32_16x16x32_bf16 v[108:111], a[20:23], a[180:183], v[108:111]
    v_and_b32 v11, s81, v47
    v_fmac_f32 v8, v220, v76
    v_mfma_f32_16x16x32_bf16 v[96:99], a[24:27], a[184:187], v[96:99]
    ds_read_b128 a[216:219], v1 offset:112
    ds_read_b128 a[220:223], v1 offset:16752
    buffer_load_dwordx4 a[124:127], v6, s[8:11], s21 offen offset:3072
    s_add_u32 s21, s21, 4096
    v_mfma_f32_16x16x32_bf16 v[104:107], a[24:27], a[188:191], v[104:107]
    v_fmac_f32 v9, v221, v77
    v_fmac_f32 v10, v222, v78
    v_fmac_f32 v11, v223, v79
    v_mfma_f32_16x16x32_bf16 v[100:103], a[28:31], a[184:187], v[100:103]
    v_cvt_pk_bf16_f32 v46, v8, v9
    v_mfma_f32_16x16x32_bf16 v[108:111], a[28:31], a[188:191], v[108:111]
    v_cvt_pk_bf16_f32 v47, v10, v11
    s_waitcnt vmcnt(20) lgkmcnt(6)
    v_mfma_f32_16x16x32_bf16 v[80:83], a[32:35], a[192:195], v[80:83]
    v_mfma_f32_16x16x32_bf16 v[88:91], a[32:35], a[196:199], v[88:91]
L_F5:
    ds_read_b128 a[224:227], v1 offset:33344
    ds_read_b128 a[228:231], v1 offset:49984
    buffer_load_dwordx4 a[0:3], v6, s[8:11], s21 offen offset:0
    ds_write_b128 v2, v[44:47] offset:50048
    s_waitcnt lgkmcnt(8)
    v_lshlrev_b32 v8, 16, v32
    v_and_b32 v9, s81, v32
    v_lshlrev_b32 v10, 16, v33
    v_mfma_f32_16x16x32_bf16 v[84:87], a[36:39], a[192:195], v[84:87]
    v_and_b32 v11, s81, v33
    v_fmac_f32 v8, v224, v48
    v_mfma_f32_16x16x32_bf16 v[92:95], a[36:39], a[196:199], v[92:95]
    v_fmac_f32 v9, v225, v49
    v_mfma_f32_16x16x32_bf16 v[80:83], a[40:43], a[200:203], v[80:83]
    ds_read_b128 a[232:235], v1 offset:33360
    ds_read_b128 a[236:239], v1 offset:50000
    buffer_load_dwordx4 a[4:7], v6, s[8:11], s21 offen offset:1024
    v_mfma_f32_16x16x32_bf16 v[88:91], a[40:43], a[204:207], v[88:91]
    v_fmac_f32 v10, v226, v50
    v_fmac_f32 v11, v227, v51
    v_mfma_f32_16x16x32_bf16 v[84:87], a[44:47], a[200:203], v[84:87]
    v_cvt_pk_bf16_f32 v32, v8, v9
    v_cvt_pk_bf16_f32 v33, v10, v11
    v_mfma_f32_16x16x32_bf16 v[92:95], a[44:47], a[204:207], v[92:95]
    v_lshlrev_b32 v8, 16, v34
    s_waitcnt vmcnt(18) lgkmcnt(5)
    v_mfma_f32_16x16x32_bf16 v[80:83], a[48:51], a[208:211], v[80:83]
    ds_read_b128 a[240:243], v1 offset:33376
    ds_read_b128 a[244:247], v1 offset:50016
    buffer_load_dwordx4 a[8:11], v6, s[8:11], s21 offen offset:2048
    v_mfma_f32_16x16x32_bf16 v[88:91], a[48:51], a[212:215], v[88:91]
    v_and_b32 v9, s81, v34
    v_lshlrev_b32 v10, 16, v35
    v_and_b32 v11, s81, v35
    v_mfma_f32_16x16x32_bf16 v[84:87], a[52:55], a[208:211], v[84:87]
    v_fmac_f32 v8, v228, v52
    v_fmac_f32 v9, v229, v53
    v_mfma_f32_16x16x32_bf16 v[92:95], a[52:55], a[212:215], v[92:95]
    v_fmac_f32 v10, v230, v54
    v_mfma_f32_16x16x32_bf16 v[80:83], a[56:59], a[216:219], v[80:83]
    ds_read_b128 a[248:251], v1 offset:33392
    ds_read_b128 a[252:255], v1 offset:50032
    buffer_load_dwordx4 a[12:15], v6, s[8:11], s21 offen offset:3072
    s_add_u32 s21, s21, 4096
    v_mfma_f32_16x16x32_bf16 v[88:91], a[56:59], a[220:223], v[88:91]
    v_fmac_f32 v11, v231, v55
    v_cvt_pk_bf16_f32 v34, v8, v9
    v_cvt_pk_bf16_f32 v35, v10, v11
    v_mfma_f32_16x16x32_bf16 v[84:87], a[60:63], a[216:219], v[84:87]
    ds_write_b128 v2, v[32:35] offset:192
    v_mfma_f32_16x16x32_bf16 v[92:95], a[60:63], a[220:223], v[92:95]
    v_lshlrev_b32 v8, 16, v36
    s_waitcnt lgkmcnt(5)
    v_mfma_f32_16x16x32_bf16 v[112:115], a[32:35], a[224:227], v[112:115]
    buffer_load_dwordx4 a[16:19], v6, s[8:11], s21 offen offset:0
    v_and_b32 v9, s81, v36
    v_mfma_f32_16x16x32_bf16 v[120:123], a[32:35], a[228:231], v[120:123]
    v_lshlrev_b32 v10, 16, v37
    v_and_b32 v11, s81, v37
    v_mfma_f32_16x16x32_bf16 v[116:119], a[36:39], a[224:227], v[116:119]
    ds_read_b128 a[192:195], v1 offset:128
    ds_read_b128 a[196:199], v1 offset:16768
    v_fmac_f32 v8, v232, v56
    v_mfma_f32_16x16x32_bf16 v[124:127], a[36:39], a[228:231], v[124:127]
    v_fmac_f32 v9, v233, v57
    v_fmac_f32 v10, v234, v58
    v_mfma_f32_16x16x32_bf16 v[112:115], a[40:43], a[232:235], v[112:115]
    ds_read_b128 a[200:203], v1 offset:144
    ds_read_b128 a[204:207], v1 offset:16784
    buffer_load_dwordx4 a[20:23], v6, s[8:11], s21 offen offset:1024
    v_mfma_f32_16x16x32_bf16 v[120:123], a[40:43], a[236:239], v[120:123]
    v_fmac_f32 v11, v235, v59
    v_cvt_pk_bf16_f32 v36, v8, v9
    v_cvt_pk_bf16_f32 v37, v10, v11
    v_mfma_f32_16x16x32_bf16 v[116:119], a[44:47], a[232:235], v[116:119]
    ds_read_b128 v[40:43], v2 offset:33472
    v_lshlrev_b32 v8, 16, v38
    v_mfma_f32_16x16x32_bf16 v[124:127], a[44:47], a[236:239], v[124:127]
    v_and_b32 v9, s81, v38
    v_lshlrev_b32 v10, 16, v39
    s_waitcnt lgkmcnt(6)
    v_mfma_f32_16x16x32_bf16 v[112:115], a[48:51], a[240:243], v[112:115]
    ds_read_b128 v[44:47], v2 offset:50112
    ds_read_b128 a[208:211], v1 offset:160
    ds_read_b128 a[212:215], v1 offset:16800
    v_mfma_f32_16x16x32_bf16 v[120:123], a[48:51], a[244:247], v[120:123]
    buffer_load_dwordx4 a[24:27], v6, s[8:11], s21 offen offset:2048
    v_and_b32 v11, s81, v39
    v_fmac_f32 v8, v236, v60
    v_mfma_f32_16x16x32_bf16 v[116:119], a[52:55], a[240:243], v[116:119]
    v_fmac_f32 v9, v237, v61
    v_fmac_f32 v10, v238, v62
    v_mfma_f32_16x16x32_bf16 v[124:127], a[52:55], a[244:247], v[124:127]
    v_fmac_f32 v11, v239, v63
    v_mfma_f32_16x16x32_bf16 v[112:115], a[56:59], a[248:251], v[112:115]
    buffer_load_dwordx4 a[28:31], v6, s[8:11], s21 offen offset:3072
    s_add_u32 s21, s21, 4096
    v_mfma_f32_16x16x32_bf16 v[120:123], a[56:59], a[252:255], v[120:123]
    v_cvt_pk_bf16_f32 v38, v8, v9
    v_cvt_pk_bf16_f32 v39, v10, v11
    v_mfma_f32_16x16x32_bf16 v[116:119], a[60:63], a[248:251], v[116:119]
    ds_read_b128 a[216:219], v1 offset:176
    ds_read_b128 a[220:223], v1 offset:16816
    ds_write_b128 v2, v[36:39] offset:16832
    v_mfma_f32_16x16x32_bf16 v[124:127], a[60:63], a[252:255], v[124:127]
    s_waitcnt lgkmcnt(6)
    v_lshlrev_b32 v8, 16, v40
    v_and_b32 v9, s81, v40
    v_lshlrev_b32 v10, 16, v41
    s_waitcnt vmcnt(20)
    v_mfma_f32_16x16x32_bf16 v[80:83], a[64:67], a[192:195], v[80:83]
    v_mfma_f32_16x16x32_bf16 v[88:91], a[64:67], a[196:199], v[88:91]
L_F6:
    buffer_load_dwordx4 a[32:35], v6, s[8:11], s21 offen offset:0
    v_and_b32 v11, s81, v41
    v_fmac_f32 v8, v240, v96
    v_fmac_f32 v9, v241, v97
    v_mfma_f32_16x16x32_bf16 v[84:87], a[68:71], a[192:195], v[84:87]
    v_fmac_f32 v10, v242, v98
    v_fmac_f32 v11, v243, v99
    v_mfma_f32_16x16x32_bf16 v[92:95], a[68:71], a[196:199], v[92:95]
    v_cvt_pk_bf16_f32 v40, v8, v9
    v_mfma_f32_16x16x32_bf16 v[80:83], a[72:75], a[200:203], v[80:83]
    buffer_load_dwordx4 a[36:39], v6, s[8:11], s21 offen offset:1024
    v_cvt_pk_bf16_f32 v41, v10, v11
    v_mfma_f32_16x16x32_bf16 v[88:91], a[72:75], a[204:207], v[88:91]
    v_lshlrev_b32 v8, 16, v42
    v_and_b32 v9, s81, v42
    v_mfma_f32_16x16x32_bf16 v[84:87], a[76:79], a[200:203], v[84:87]
    s_waitcnt lgkmcnt(0)
    s_barrier
    ds_read_b128 a[224:227], v1 offset:192
    ds_read_b128 a[228:231], v1 offset:16832
    ds_read_b128 a[232:235], v1 offset:208
    v_mfma_f32_16x16x32_bf16 v[92:95], a[76:79], a[204:207], v[92:95]
    ds_read_b128 a[236:239], v1 offset:16848
    v_lshlrev_b32 v10, 16, v43
    v_and_b32 v11, s81, v43
    v_fmac_f32 v8, v244, v100
    s_waitcnt vmcnt(18)
    v_mfma_f32_16x16x32_bf16 v[80:83], a[80:83], a[208:211], v[80:83]
    ds_read_b128 a[240:243], v1 offset:224
    ds_read_b128 a[244:247], v1 offset:16864
    buffer_load_dwordx4 a[40:43], v6, s[8:11], s21 offen offset:2048
    v_mfma_f32_16x16x32_bf16 v[88:91], a[80:83], a[212:215], v[88:91]
    v_fmac_f32 v9, v245, v101
    v_fmac_f32 v10, v246, v102
    v_fmac_f32 v11, v247, v103
    v_mfma_f32_16x16x32_bf16 v[84:87], a[84:87], a[208:211], v[84:87]
    v_cvt_pk_bf16_f32 v42, v8, v9
    v_mfma_f32_16x16x32_bf16 v[92:95], a[84:87], a[212:215], v[92:95]
    v_cvt_pk_bf16_f32 v43, v10, v11
    v_mfma_f32_16x16x32_bf16 v[80:83], a[88:91], a[216:219], v[80:83]
    ds_read_b128 a[248:251], v1 offset:240
    ds_read_b128 a[252:255], v1 offset:16880
    buffer_load_dwordx4 a[44:47], v6, s[8:11], s21 offen offset:3072
    s_add_u32 s21, s21, 4096
    v_mfma_f32_16x16x32_bf16 v[88:91], a[88:91], a[220:223], v[88:91]
    ds_write_b128 v2, v[40:43] offset:33472
    v_lshlrev_b32 v8, 16, v44
    v_and_b32 v9, s81, v44
    v_lshlrev_b32 v10, 16, v45
    v_mfma_f32_16x16x32_bf16 v[84:87], a[92:95], a[216:219], v[84:87]
    v_and_b32 v11, s81, v45
    v_fmac_f32 v8, v248, v104
    v_mfma_f32_16x16x32_bf16 v[92:95], a[92:95], a[220:223], v[92:95]
    v_fmac_f32 v9, v249, v105
    s_waitcnt vmcnt(16) lgkmcnt(5)
    v_mfma_f32_16x16x32_bf16 v[80:83], a[96:99], a[224:227], v[80:83]
    ds_read_b128 a[192:195], v1 offset:33408
    ds_read_b128 a[196:199], v1 offset:50048
    buffer_load_dwordx4 a[48:51], v6, s[8:11], s21 offen offset:0
    v_mfma_f32_16x16x32_bf16 v[88:91], a[96:99], a[228:231], v[88:91]
    v_fmac_f32 v10, v250, v106
    v_fmac_f32 v11, v251, v107
    v_cvt_pk_bf16_f32 v44, v8, v9
    v_mfma_f32_16x16x32_bf16 v[84:87], a[100:103], a[224:227], v[84:87]
    v_cvt_pk_bf16_f32 v45, v10, v11
    v_lshlrev_b32 v8, 16, v46
    v_mfma_f32_16x16x32_bf16 v[92:95], a[100:103], a[228:231], v[92:95]
    v_and_b32 v9, s81, v46
    v_mfma_f32_16x16x32_bf16 v[80:83], a[104:107], a[232:235], v[80:83]
    ds_read_b128 a[200:203], v1 offset:33424
    ds_read_b128 a[204:207], v1 offset:50064
    buffer_load_dwordx4 a[52:55], v6, s[8:11], s21 offen offset:1024
    v_mfma_f32_16x16x32_bf16 v[88:91], a[104:107], a[236:239], v[88:91]
    v_lshlrev_b32 v10, 16, v47
    v_and_b32 v11, s81, v47
    v_fmac_f32 v8, v252, v108
    v_mfma_f32_16x16x32_bf16 v[84:87], a[108:111], a[232:235], v[84:87]
    v_fmac_f32 v9, v253, v109
    v_fmac_f32 v10, v254, v110
    v_mfma_f32_16x16x32_bf16 v[92:95], a[108:111], a[236:239], v[92:95]
    v_fmac_f32 v11, v255, v111
    s_waitcnt vmcnt(14) lgkmcnt(5)
    v_mfma_f32_16x16x32_bf16 v[80:83], a[112:115], a[240:243], v[80:83]
    buffer_load_dwordx4 a[56:59], v6, s[8:11], s21 offen offset:2048
    v_cvt_pk_bf16_f32 v46, v8, v9
    v_mfma_f32_16x16x32_bf16 v[88:91], a[112:115], a[244:247], v[88:91]
    v_cvt_pk_bf16_f32 v47, v10, v11
    v_mfma_f32_16x16x32_bf16 v[84:87], a[116:119], a[240:243], v[84:87]
    ds_read_b128 a[208:211], v1 offset:33440
    ds_read_b128 a[212:215], v1 offset:50080
    v_mfma_f32_16x16x32_bf16 v[92:95], a[116:119], a[244:247], v[92:95]
    ds_write_b128 v2, v[44:47] offset:50112
    v_mfma_f32_16x16x32_bf16 v[80:83], a[120:123], a[248:251], v[80:83]
    buffer_load_dwordx4 a[60:63], v6, s[8:11], s21 offen offset:3072
    v_mfma_f32_16x16x32_bf16 v[88:91], a[120:123], a[252:255], v[88:91]
    s_add_u32 s21, s21, 4096
    v_mfma_f32_16x16x32_bf16 v[84:87], a[124:127], a[248:251], v[84:87]
    ds_read_b128 a[216:219], v1 offset:33456
    v_mfma_f32_16x16x32_bf16 v[92:95], a[124:127], a[252:255], v[92:95]
    ds_read_b128 a[220:223], v1 offset:50096
    s_waitcnt lgkmcnt(5)
    v_mfma_f32_16x16x32_bf16 v[112:115], a[64:67], a[192:195], v[112:115]
    v_mfma_f32_16x16x32_bf16 v[120:123], a[64:67], a[196:199], v[120:123]
L_F7:
    buffer_load_dwordx4 a[64:67], v6, s[8:11], s21 offen offset:0
    v_mfma_f32_16x16x32_bf16 v[116:119], a[68:71], a[192:195], v[116:119]
    s_waitcnt lgkmcnt(2)
    s_barrier
    ds_read_b128 a[224:227], v1 offset:33472
    v_mfma_f32_16x16x32_bf16 v[124:127], a[68:71], a[196:199], v[124:127]
    ds_read_b128 a[228:231], v1 offset:50112
    v_mfma_f32_16x16x32_bf16 v[112:115], a[72:75], a[200:203], v[112:115]
    ds_read_b128 a[232:235], v1 offset:33488
    ds_read_b128 a[236:239], v1 offset:50128
    buffer_load_dwordx4 a[68:71], v6, s[8:11], s21 offen offset:1024
    v_cvt_pk_bf16_f32 v80, v80, v81
    v_mfma_f32_16x16x32_bf16 v[120:123], a[72:75], a[204:207], v[120:123]
    v_cvt_pk_bf16_f32 v81, v82, v83
    v_cvt_pk_bf16_f32 v82, v84, v85
    v_cvt_pk_bf16_f32 v83, v86, v87
    v_mfma_f32_16x16x32_bf16 v[116:119], a[76:79], a[200:203], v[116:119]
    ds_write_b128 v4, v[80:83] offset:0
    v_cvt_pk_bf16_f32 v84, v88, v89
    v_cvt_pk_bf16_f32 v85, v90, v91
    v_mfma_f32_16x16x32_bf16 v[124:127], a[76:79], a[204:207], v[124:127]
    v_cvt_pk_bf16_f32 v86, v92, v93
    v_cvt_pk_bf16_f32 v87, v94, v95
    s_waitcnt lgkmcnt(5)
    v_mfma_f32_16x16x32_bf16 v[112:115], a[80:83], a[208:211], v[112:115]
    buffer_load_dwordx4 a[72:75], v6, s[8:11], s21 offen offset:2048
    v_mfma_f32_16x16x32_bf16 v[120:123], a[80:83], a[212:215], v[120:123]
    v_mfma_f32_16x16x32_bf16 v[116:119], a[84:87], a[208:211], v[116:119]
    ds_read_b128 a[240:243], v1 offset:33504
    ds_read_b128 a[244:247], v1 offset:50144
    ds_read_b128 v[16:19], v5 offset:0
    v_mfma_f32_16x16x32_bf16 v[124:127], a[84:87], a[212:215], v[124:127]
    ds_read_b128 v[20:23], v5 offset:16
    ds_write_b128 v4, v[84:87] offset:1280
    v_mfma_f32_16x16x32_bf16 v[112:115], a[88:91], a[216:219], v[112:115]
    buffer_load_dwordx4 a[76:79], v6, s[8:11], s21 offen offset:3072
    v_mfma_f32_16x16x32_bf16 v[120:123], a[88:91], a[220:223], v[120:123]
    s_add_u32 s21, s21, 4096
    v_mfma_f32_16x16x32_bf16 v[116:119], a[92:95], a[216:219], v[116:119]
    s_waitcnt lgkmcnt(0)
    s_barrier
    ds_read_b128 a[248:251], v1 offset:33520
    v_mfma_f32_16x16x32_bf16 v[124:127], a[92:95], a[220:223], v[124:127]
    ds_read_b128 a[252:255], v1 offset:50160
    v_mfma_f32_16x16x32_bf16 v[112:115], a[96:99], a[224:227], v[112:115]
    ds_read_b128 a[128:131], v3 offset:0
    ds_read_b128 a[132:135], v3 offset:1280
    v_mfma_f32_16x16x32_bf16 v[120:123], a[96:99], a[228:231], v[120:123]
    buffer_load_dwordx4 a[80:83], v6, s[8:11], s21 offen offset:0
    v_mfma_f32_16x16x32_bf16 v[116:119], a[100:103], a[224:227], v[116:119]
    ds_read_b128 a[136:139], v3 offset:16
    v_mfma_f32_16x16x32_bf16 v[124:127], a[100:103], a[228:231], v[124:127]
    v_mfma_f32_16x16x32_bf16 v[112:115], a[104:107], a[232:235], v[112:115]
    ds_read_b128 a[140:143], v3 offset:1296
    v_mfma_f32_16x16x32_bf16 v[120:123], a[104:107], a[236:239], v[120:123]
    buffer_load_dwordx4 a[84:87], v6, s[8:11], s21 offen offset:1024
    v_mfma_f32_16x16x32_bf16 v[116:119], a[108:111], a[232:235], v[116:119]
    ds_read_b128 a[144:147], v3 offset:32
    v_mfma_f32_16x16x32_bf16 v[124:127], a[108:111], a[236:239], v[124:127]
    s_waitcnt lgkmcnt(5)
    v_mfma_f32_16x16x32_bf16 v[112:115], a[112:115], a[240:243], v[112:115]
    ds_read_b128 a[148:151], v3 offset:1312
    v_mfma_f32_16x16x32_bf16 v[120:123], a[112:115], a[244:247], v[120:123]
    buffer_load_dwordx4 a[88:91], v6, s[8:11], s21 offen offset:2048
    v_mfma_f32_16x16x32_bf16 v[116:119], a[116:119], a[240:243], v[116:119]
    ds_read_b128 a[152:155], v3 offset:48
    v_mfma_f32_16x16x32_bf16 v[124:127], a[116:119], a[244:247], v[124:127]
    v_mfma_f32_16x16x32_bf16 v[112:115], a[120:123], a[248:251], v[112:115]
    ds_read_b128 a[156:159], v3 offset:1328
    buffer_load_dwordx4 a[92:95], v6, s[8:11], s21 offen offset:3072
    v_mfma_f32_16x16x32_bf16 v[120:123], a[120:123], a[252:255], v[120:123]
    s_add_u32 s21, s21, 4096
    v_mfma_f32_16x16x32_bf16 v[116:119], a[124:127], a[248:251], v[116:119]
    v_mfma_f32_16x16x32_bf16 v[124:127], a[124:127], a[252:255], v[124:127]
    s_add_u32 s22, s22, 1
    s_cmp_lt_u32 s22, 5
    s_cbranch_scc1 L_Ftop
    buffer_load_dwordx4 a[96:99], v6, s[8:11], s21 offen offset:0
    buffer_load_dwordx4 a[100:103], v6, s[8:11], s21 offen offset:1024
    buffer_load_dwordx4 a[104:107], v6, s[8:11], s21 offen offset:2048
    buffer_load_dwordx4 a[108:111], v6, s[8:11], s21 offen offset:3072
    s_add_u32 s21, s21, 4096
    buffer_load_dwordx4 a[112:115], v6, s[8:11], s21 offen offset:0
    buffer_load_dwordx4 a[116:119], v6, s[8:11], s21 offen offset:1024
    buffer_load_dwordx4 a[120:123], v6, s[8:11], s21 offen offset:2048
    buffer_load_dwordx4 a[124:127], v6, s[8:11], s21 offen offset:3072
    s_add_u32 s21, s21, 4096
L_fin:
    v_mbcnt_lo_u32_b32 v13, -1, 0
    v_mbcnt_hi_u32_b32 v13, -1, v13
    v_lshrrev_b32 v7, 3, v13
    v_and_b32 v13, 7, v13
    v_lshlrev_b32 v13, 4, v13
    s_lshl_b32 s23, s20, 8
    v_add_u32 v13, s23, v13
    v_lshl_add_u32 v12, v7, 10, v13
    v_mul_u32_u24 v7, 1040, v7
    v_add_u32 v7, v7, v13
    s_lshl_b32 s23, s2, 16
    s_waitcnt vmcnt(28) lgkmcnt(7)
    v_mfma_f32_16x16x32_bf16 v[48:51], a[0:3], a[128:131], v[16:19]
    s_waitcnt lgkmcnt(6)
    v_mfma_f32_16x16x32_bf16 v[56:59], a[0:3], a[132:135], v[16:19]
    v_mfma_f32_16x16x32_bf16 v[52:55], a[4:7], a[128:131], v[20:23]
    v_mfma_f32_16x16x32_bf16 v[60:63], a[4:7], a[132:135], v[20:23]
    s_waitcnt lgkmcnt(5)
    v_mfma_f32_16x16x32_bf16 v[48:51], a[8:11], a[136:139], v[48:51]
    v_cvt_pk_bf16_f32 v112, v112, v113
    v_cvt_pk_bf16_f32 v113, v114, v115
    s_waitcnt lgkmcnt(4)
    v_mfma_f32_16x16x32_bf16 v[56:59], a[8:11], a[140:143], v[56:59]
    v_cvt_pk_bf16_f32 v114, v116, v117
    v_cvt_pk_bf16_f32 v115, v118, v119
    v_mfma_f32_16x16x32_bf16 v[52:55], a[12:15], a[136:139], v[52:55]
    ds_write_b128 v4, v[112:115] offset:2560
    v_cvt_pk_bf16_f32 v116, v120, v121
    v_cvt_pk_bf16_f32 v117, v122, v123
    v_mfma_f32_16x16x32_bf16 v[60:63], a[12:15], a[140:143], v[60:63]
    v_cvt_pk_bf16_f32 v118, v124, v125
    v_cvt_pk_bf16_f32 v119, v126, v127
    s_waitcnt vmcnt(24) lgkmcnt(4)
    v_mfma_f32_16x16x32_bf16 v[48:51], a[16:19], a[144:147], v[48:51]
    s_waitcnt lgkmcnt(3)
    v_mfma_f32_16x16x32_bf16 v[56:59], a[16:19], a[148:151], v[56:59]
    v_mfma_f32_16x16x32_bf16 v[52:55], a[20:23], a[144:147], v[52:55]
    ds_read_b128 v[24:27], v5 offset:128
    ds_read_b128 v[28:31], v5 offset:144
    v_mfma_f32_16x16x32_bf16 v[60:63], a[20:23], a[148:151], v[60:63]
    ds_write_b128 v4, v[116:119] offset:3840
    s_waitcnt lgkmcnt(5)
    v_mfma_f32_16x16x32_bf16 v[48:51], a[24:27], a[152:155], v[48:51]
    s_waitcnt lgkmcnt(4)
    v_mfma_f32_16x16x32_bf16 v[56:59], a[24:27], a[156:159], v[56:59]
    v_mfma_f32_16x16x32_bf16 v[52:55], a[28:31], a[152:155], v[52:55]
    s_waitcnt lgkmcnt(0)
    s_barrier
    ds_read_b128 v[32:35], v2 offset:0
    v_mfma_f32_16x16x32_bf16 v[60:63], a[28:31], a[156:159], v[60:63]
    ds_read_b128 v[36:39], v2 offset:16640
    s_waitcnt vmcnt(20)
    v_mfma_f32_16x16x32_bf16 v[64:67], a[32:35], a[128:131], v[24:27]
    ds_read_b128 a[160:163], v3 offset:2560
    v_mfma_f32_16x16x32_bf16 v[72:75], a[32:35], a[132:135], v[24:27]
    ds_read_b128 a[164:167], v3 offset:3840
    v_mfma_f32_16x16x32_bf16 v[68:71], a[36:39], a[128:131], v[28:31]
    ds_read_b128 a[168:171], v3 offset:2576
    v_mfma_f32_16x16x32_bf16 v[76:79], a[36:39], a[132:135], v[28:31]
    v_mfma_f32_16x16x32_bf16 v[64:67], a[40:43], a[136:139], v[64:67]
    ds_read_b128 a[172:175], v3 offset:3856
    s_waitcnt lgkmcnt(5)
    v_lshlrev_b32 v8, 16, v32
    v_and_b32 v9, s81, v32
    v_lshlrev_b32 v10, 16, v33
    v_mfma_f32_16x16x32_bf16 v[72:75], a[40:43], a[140:143], v[72:75]
    v_and_b32 v11, s81, v33
    v_fmac_f32 v8, v128, v48
    v_fmac_f32 v9, v129, v49
    v_mfma_f32_16x16x32_bf16 v[68:71], a[44:47], a[136:139], v[68:71]
    ds_read_b128 a[176:179], v3 offset:2592
    ds_read_b128 a[180:183], v3 offset:3872
    v_fmac_f32 v10, v130, v50
    v_fmac_f32 v11, v131, v51
    v_mfma_f32_16x16x32_bf16 v[76:79], a[44:47], a[140:143], v[76:79]
    v_cvt_pk_bf16_f32 v32, v8, v9
    v_cvt_pk_bf16_f32 v33, v10, v11
    v_lshlrev_b32 v8, 16, v34
    s_waitcnt vmcnt(16)
    v_mfma_f32_16x16x32_bf16 v[64:67], a[48:51], a[144:147], v[64:67]
    ds_read_b128 a[184:187], v3 offset:2608
    v_and_b32 v9, s81, v34
    v_lshlrev_b32 v10, 16, v35
    v_mfma_f32_16x16x32_bf16 v[72:75], a[48:51], a[148:151], v[72:75]
    v_and_b32 v11, s81, v35
    v_fmac_f32 v8, v132, v52
    v_fmac_f32 v9, v133, v53
    v_mfma_f32_16x16x32_bf16 v[68:71], a[52:55], a[144:147], v[68:71]
    ds_read_b128 a[188:191], v3 offset:3888
    v_fmac_f32 v10, v134, v54
    v_fmac_f32 v11, v135, v55
    v_mfma_f32_16x16x32_bf16 v[76:79], a[52:55], a[148:151], v[76:79]
    v_cvt_pk_bf16_f32 v34, v8, v9
    v_cvt_pk_bf16_f32 v35, v10, v11
    v_mfma_f32_16x16x32_bf16 v[64:67], a[56:59], a[152:155], v[64:67]
    ds_read_b128 v[40:43], v2 offset:64
    ds_write_b128 v2, v[32:35] offset:0
    s_waitcnt lgkmcnt(10)
    v_lshlrev_b32 v8, 16, v36
    v_and_b32 v9, s81, v36
    v_mfma_f32_16x16x32_bf16 v[72:75], a[56:59], a[156:159], v[72:75]
    v_lshlrev_b32 v10, 16, v37
    v_and_b32 v11, s81, v37
    v_fmac_f32 v8, v136, v56
    v_fmac_f32 v9, v137, v57
    v_mfma_f32_16x16x32_bf16 v[68:71], a[60:63], a[152:155], v[68:71]
    v_fmac_f32 v10, v138, v58
    v_fmac_f32 v11, v139, v59
    v_cvt_pk_bf16_f32 v36, v8, v9
    v_mfma_f32_16x16x32_bf16 v[76:79], a[60:63], a[156:159], v[76:79]
    v_cvt_pk_bf16_f32 v37, v10, v11
    v_lshlrev_b32 v8, 16, v38
    s_waitcnt lgkmcnt(9)
    v_mfma_f32_16x16x32_bf16 v[80:83], a[0:3], a[160:163], v[16:19]
    ds_read_b128 v[44:47], v2 offset:16704
    v_and_b32 v9, s81, v38
    v_lshlrev_b32 v10, 16, v39
    s_waitcnt lgkmcnt(9)
    v_mfma_f32_16x16x32_bf16 v[88:91], a[0:3], a[164:167], v[16:19]
    v_and_b32 v11, s81, v39
    v_fmac_f32 v8, v140, v60
    v_fmac_f32 v9, v141, v61
    v_mfma_f32_16x16x32_bf16 v[84:87], a[4:7], a[160:163], v[20:23]
    v_fmac_f32 v10, v142, v62
    v_fmac_f32 v11, v143, v63
    v_mfma_f32_16x16x32_bf16 v[92:95], a[4:7], a[164:167], v[20:23]
    v_cvt_pk_bf16_f32 v38, v8, v9
    v_cvt_pk_bf16_f32 v39, v10, v11
    s_waitcnt lgkmcnt(8)
    v_mfma_f32_16x16x32_bf16 v[80:83], a[8:11], a[168:171], v[80:83]
    ds_read_b128 v[16:19], v5 offset:256
    ds_write_b128 v2, v[36:39] offset:16640
    s_waitcnt lgkmcnt(4)
    v_lshlrev_b32 v8, 16, v40
    v_and_b32 v9, s81, v40
    v_mfma_f32_16x16x32_bf16 v[88:91], a[8:11], a[172:175], v[88:91]
    v_lshlrev_b32 v10, 16, v41
    v_and_b32 v11, s81, v41
    v_fmac_f32 v8, v160, v64
    v_fmac_f32 v9, v161, v65
    v_mfma_f32_16x16x32_bf16 v[84:87], a[12:15], a[168:171], v[84:87]
    v_fmac_f32 v10, v162, v66
    v_fmac_f32 v11, v163, v67
    v_cvt_pk_bf16_f32 v40, v8, v9
    v_mfma_f32_16x16x32_bf16 v[92:95], a[12:15], a[172:175], v[92:95]
    v_cvt_pk_bf16_f32 v41, v10, v11
    v_lshlrev_b32 v8, 16, v42
    v_mfma_f32_16x16x32_bf16 v[80:83], a[16:19], a[176:179], v[80:83]
    ds_read_b128 v[20:23], v5 offset:272
    v_and_b32 v9, s81, v42
    v_lshlrev_b32 v10, 16, v43
    v_mfma_f32_16x16x32_bf16 v[88:91], a[16:19], a[180:183], v[88:91]
    v_and_b32 v11, s81, v43
    v_fmac_f32 v8, v164, v68
    v_fmac_f32 v9, v165, v69
    v_mfma_f32_16x16x32_bf16 v[84:87], a[20:23], a[176:179], v[84:87]
    v_fmac_f32 v10, v166, v70
    v_fmac_f32 v11, v167, v71
    v_mfma_f32_16x16x32_bf16 v[92:95], a[20:23], a[180:183], v[92:95]
    v_cvt_pk_bf16_f32 v42, v8, v9
    v_cvt_pk_bf16_f32 v43, v10, v11
    v_mfma_f32_16x16x32_bf16 v[80:83], a[24:27], a[184:187], v[80:83]
    ds_read_b128 v[32:35], v2 offset:33280
    ds_write_b128 v2, v[40:43] offset:64
    s_waitcnt lgkmcnt(5)
    v_lshlrev_b32 v8, 16, v44
    v_and_b32 v9, s81, v44
    v_mfma_f32_16x16x32_bf16 v[88:91], a[24:27], a[188:191], v[88:91]
    v_lshlrev_b32 v10, 16, v45
    v_and_b32 v11, s81, v45
    v_fmac_f32 v8, v168, v72
    v_fmac_f32 v9, v169, v73
    v_mfma_f32_16x16x32_bf16 v[84:87], a[28:31], a[184:187], v[84:87]
    v_fmac_f32 v10, v170, v74
    v_fmac_f32 v11, v171, v75
    v_cvt_pk_bf16_f32 v44, v8, v9
    v_mfma_f32_16x16x32_bf16 v[92:95], a[28:31], a[188:191], v[92:95]
    v_cvt_pk_bf16_f32 v45, v10, v11
    v_lshlrev_b32 v8, 16, v46
    v_mfma_f32_16x16x32_bf16 v[96:99], a[32:35], a[160:163], v[24:27]
    ds_read_b128 v[36:39], v2 offset:49920
    v_and_b32 v9, s81, v46
    v_lshlrev_b32 v10, 16, v47
    v_mfma_f32_16x16x32_bf16 v[104:107], a[32:35], a[164:167], v[24:27]
    v_and_b32 v11, s81, v47
    v_fmac_f32 v8, v172, v76
    v_fmac_f32 v9, v173, v77
    v_mfma_f32_16x16x32_bf16 v[100:103], a[36:39], a[160:163], v[28:31]
    v_fmac_f32 v10, v174, v78
    v_fmac_f32 v11, v175, v79
    v_mfma_f32_16x16x32_bf16 v[108:111], a[36:39], a[164:167], v[28:31]
    v_cvt_pk_bf16_f32 v46, v8, v9
    v_cvt_pk_bf16_f32 v47, v10, v11
    v_mfma_f32_16x16x32_bf16 v[96:99], a[40:43], a[168:171], v[96:99]
    ds_read_b128 v[24:27], v5 offset:384
    ds_write_b128 v2, v[44:47] offset:16704
    s_waitcnt lgkmcnt(4)
    v_lshlrev_b32 v8, 16, v32
    v_and_b32 v9, s81, v32
    v_mfma_f32_16x16x32_bf16 v[104:107], a[40:43], a[172:175], v[104:107]
    v_lshlrev_b32 v10, 16, v33
    v_and_b32 v11, s81, v33
    v_fmac_f32 v8, v144, v80
    v_fmac_f32 v9, v145, v81
    v_mfma_f32_16x16x32_bf16 v[100:103], a[44:47], a[168:171], v[100:103]
    v_fmac_f32 v10, v146, v82
    v_fmac_f32 v11, v147, v83
    v_cvt_pk_bf16_f32 v32, v8, v9
    v_mfma_f32_16x16x32_bf16 v[108:111], a[44:47], a[172:175], v[108:111]
    v_cvt_pk_bf16_f32 v33, v10, v11
    v_lshlrev_b32 v8, 16, v34
    v_mfma_f32_16x16x32_bf16 v[96:99], a[48:51], a[176:179], v[96:99]
    ds_read_b128 a[192:195], v7 offset:0
    ds_read_b128 a[196:199], v7 offset:8320
    ds_read_b128 a[200:203], v7 offset:16640
    ds_read_b128 v[28:31], v5 offset:400
    ds_read_b128 a[204:207], v7 offset:24960
    s_add_u32 s24, s23, 0
    v_mfma_f32_16x16x32_bf16 v[104:107], a[48:51], a[180:183], v[104:107]
    v_and_b32 v9, s81, v34
    v_lshlrev_b32 v10, 16, v35
    v_and_b32 v11, s81, v35
    v_fmac_f32 v8, v148, v84
    v_fmac_f32 v9, v149, v85
    v_mfma_f32_16x16x32_bf16 v[100:103], a[52:55], a[176:179], v[100:103]
    s_waitcnt lgkmcnt(4)
    buffer_store_dwordx4 a[192:195], v12, s[12:15], s24 offen offset:0
    v_fmac_f32 v10, v150, v86
    v_fmac_f32 v11, v151, v87
    v_mfma_f32_16x16x32_bf16 v[108:111], a[52:55], a[180:183], v[108:111]
    v_cvt_pk_bf16_f32 v34, v8, v9
    v_cvt_pk_bf16_f32 v35, v10, v11
    v_mfma_f32_16x16x32_bf16 v[96:99], a[56:59], a[184:187], v[96:99]
    ds_read_b128 v[40:43], v2 offset:33344
    s_add_u32 s24, s23, 8192
    s_waitcnt lgkmcnt(4)
    buffer_store_dwordx4 a[196:199], v12, s[12:15], s24 offen offset:0
    ds_write_b128 v2, v[32:35] offset:33280
    v_lshlrev_b32 v8, 16, v36
    v_mfma_f32_16x16x32_bf16 v[104:107], a[56:59], a[188:191], v[104:107]
    v_and_b32 v9, s81, v36
    v_lshlrev_b32 v10, 16, v37
    v_and_b32 v11, s81, v37
    v_fmac_f32 v8, v152, v88
    v_fmac_f32 v9, v153, v89
    v_mfma_f32_16x16x32_bf16 v[100:103], a[60:63], a[184:187], v[100:103]
    s_add_u32 s24, s23, 16384
    v_fmac_f32 v10, v154, v90
    v_fmac_f32 v11, v155, v91
    v_mfma_f32_16x16x32_bf16 v[108:111], a[60:63], a[188:191], v[108:111]
    v_cvt_pk_bf16_f32 v36, v8, v9
    v_cvt_pk_bf16_f32 v37, v10, v11
    v_lshlrev_b32 v8, 16, v38
    s_waitcnt vmcnt(14)
    v_mfma_f32_16x16x32_bf16 v[48:51], a[64:67], a[128:131], v[16:19]
    ds_read_b128 v[44:47], v2 offset:49984
    s_waitcnt lgkmcnt(5)
    buffer_store_dwordx4 a[200:203], v12, s[12:15], s24 offen offset:0
    s_add_u32 s24, s23, 24576
    v_and_b32 v9, s81, v38
    v_mfma_f32_16x16x32_bf16 v[56:59], a[64:67], a[132:135], v[16:19]
    v_lshlrev_b32 v10, 16, v39
    v_and_b32 v11, s81, v39
    v_fmac_f32 v8, v156, v92
    v_fmac_f32 v9, v157, v93
    v_mfma_f32_16x16x32_bf16 v[52:55], a[68:71], a[128:131], v[20:23]
    s_waitcnt lgkmcnt(3)
    buffer_store_dwordx4 a[204:207], v12, s[12:15], s24 offen offset:0
    v_fmac_f32 v10, v158, v94
    v_fmac_f32 v11, v159, v95
    v_mfma_f32_16x16x32_bf16 v[60:63], a[68:71], a[132:135], v[20:23]
    v_cvt_pk_bf16_f32 v38, v8, v9
    v_cvt_pk_bf16_f32 v39, v10, v11
    v_mfma_f32_16x16x32_bf16 v[48:51], a[72:75], a[136:139], v[48:51]
    ds_write_b128 v2, v[36:39] offset:49920
    s_waitcnt lgkmcnt(3)
    v_lshlrev_b32 v8, 16, v40
    v_and_b32 v9, s81, v40
    v_lshlrev_b32 v10, 16, v41
    v_mfma_f32_16x16x32_bf16 v[56:59], a[72:75], a[140:143], v[56:59]
    v_and_b32 v11, s81, v41
    v_fmac_f32 v8, v176, v96
    v_fmac_f32 v9, v177, v97
    v_mfma_f32_16x16x32_bf16 v[52:55], a[76:79], a[136:139], v[52:55]
    v_fmac_f32 v10, v178, v98
    v_fmac_f32 v11, v179, v99
    v_cvt_pk_bf16_f32 v40, v8, v9
    v_mfma_f32_16x16x32_bf16 v[60:63], a[76:79], a[140:143], v[60:63]
    v_cvt_pk_bf16_f32 v41, v10, v11
    v_lshlrev_b32 v8, 16, v42
    s_waitcnt vmcnt(12)
    v_mfma_f32_16x16x32_bf16 v[48:51], a[80:83], a[144:147], v[48:51]
    v_and_b32 v9, s81, v42
    v_lshlrev_b32 v10, 16, v43
    v_and_b32 v11, s81, v43
    v_mfma_f32_16x16x32_bf16 v[56:59], a[80:83], a[148:151], v[56:59]
    v_fmac_f32 v8, v180, v100
    v_fmac_f32 v9, v181, v101
    v_mfma_f32_16x16x32_bf16 v[52:55], a[84:87], a[144:147], v[52:55]
    v_fmac_f32 v10, v182, v102
    v_fmac_f32 v11, v183, v103
    v_mfma_f32_16x16x32_bf16 v[60:63], a[84:87], a[148:151], v[60:63]
    v_cvt_pk_bf16_f32 v42, v8, v9
    v_cvt_pk_bf16_f32 v43, v10, v11
    v_mfma_f32_16x16x32_bf16 v[48:51], a[88:91], a[152:155], v[48:51]
    ds_read_b128 v[32:35], v2 offset:128
    ds_write_b128 v2, v[40:43] offset:33344
    s_waitcnt lgkmcnt(3)
    v_lshlrev_b32 v8, 16, v44
    v_and_b32 v9, s81, v44
    v_mfma_f32_16x16x32_bf16 v[56:59], a[88:91], a[156:159], v[56:59]
    v_lshlrev_b32 v10, 16, v45
    v_and_b32 v11, s81, v45
    v_fmac_f32 v8, v184, v104
    v_fmac_f32 v9, v185, v105
    v_mfma_f32_16x16x32_bf16 v[52:55], a[92:95], a[152:155], v[52:55]
    v_fmac_f32 v10, v186, v106
    v_fmac_f32 v11, v187, v107
    v_cvt_pk_bf16_f32 v44, v8, v9
    v_mfma_f32_16x16x32_bf16 v[60:63], a[92:95], a[156:159], v[60:63]
    v_cvt_pk_bf16_f32 v45, v10, v11
    v_lshlrev_b32 v8, 16, v46
    s_waitcnt vmcnt(8)
    v_mfma_f32_16x16x32_bf16 v[64:67], a[96:99], a[128:131], v[24:27]
    ds_read_b128 v[36:39], v2 offset:16768
    v_and_b32 v9, s81, v46
    v_lshlrev_b32 v10, 16, v47
    v_mfma_f32_16x16x32_bf16 v[72:75], a[96:99], a[132:135], v[24:27]
    v_and_b32 v11, s81, v47
    v_fmac_f32 v8, v188, v108
    v_fmac_f32 v9, v189, v109
    v_mfma_f32_16x16x32_bf16 v[68:71], a[100:103], a[128:131], v[28:31]
    v_fmac_f32 v10, v190, v110
    v_fmac_f32 v11, v191, v111
    v_mfma_f32_16x16x32_bf16 v[76:79], a[100:103], a[132:135], v[28:31]
    v_cvt_pk_bf16_f32 v46, v8, v9
    v_cvt_pk_bf16_f32 v47, v10, v11
    v_mfma_f32_16x16x32_bf16 v[64:67], a[104:107], a[136:139], v[64:67]
    ds_write_b128 v2, v[44:47] offset:49984
    s_waitcnt lgkmcnt(3)
    v_lshlrev_b32 v8, 16, v32
    v_and_b32 v9, s81, v32
    v_lshlrev_b32 v10, 16, v33
    v_mfma_f32_16x16x32_bf16 v[72:75], a[104:107], a[140:143], v[72:75]
    v_and_b32 v11, s81, v33
    v_fmac_f32 v8, v192, v48
    v_fmac_f32 v9, v193, v49
    v_mfma_f32_16x16x32_bf16 v[68:71], a[108:111], a[136:139], v[68:71]
    v_fmac_f32 v10, v194, v50
    v_fmac_f32 v11, v195, v51
    v_cvt_pk_bf16_f32 v32, v8, v9
    v_mfma_f32_16x16x32_bf16 v[76:79], a[108:111], a[140:143], v[76:79]
    v_cvt_pk_bf16_f32 v33, v10, v11
    v_lshlrev_b32 v8, 16, v34
    s_waitcnt vmcnt(4)
    v_mfma_f32_16x16x32_bf16 v[64:67], a[112:115], a[144:147], v[64:67]
    ds_read_b128 a[208:211], v7 offset:33280
    ds_read_b128 a[212:215], v7 offset:41600
    ds_read_b128 a[216:219], v7 offset:49920
    ds_read_b128 a[220:223], v7 offset:58240
    s_add_u32 s24, s23, 32768
    v_mfma_f32_16x16x32_bf16 v[72:75], a[112:115], a[148:151], v[72:75]
    v_and_b32 v9, s81, v34
    v_lshlrev_b32 v10, 16, v35
    v_and_b32 v11, s81, v35
    v_fmac_f32 v8, v196, v52
    v_fmac_f32 v9, v197, v53
    v_mfma_f32_16x16x32_bf16 v[68:71], a[116:119], a[144:147], v[68:71]
    s_waitcnt lgkmcnt(3)
    buffer_store_dwordx4 a[208:211], v12, s[12:15], s24 offen offset:0
    v_fmac_f32 v10, v198, v54
    v_fmac_f32 v11, v199, v55
    v_mfma_f32_16x16x32_bf16 v[76:79], a[116:119], a[148:151], v[76:79]
    v_cvt_pk_bf16_f32 v34, v8, v9
    v_cvt_pk_bf16_f32 v35, v10, v11
    v_mfma_f32_16x16x32_bf16 v[64:67], a[120:123], a[152:155], v[64:67]
    ds_read_b128 v[40:43], v2 offset:192
    s_add_u32 s24, s23, 40960
    s_waitcnt lgkmcnt(3)
    buffer_store_dwordx4 a[212:215], v12, s[12:15], s24 offen offset:0
    ds_write_b128 v2, v[32:35] offset:128
    v_lshlrev_b32 v8, 16, v36
    v_mfma_f32_16x16x32_bf16 v[72:75], a[120:123], a[156:159], v[72:75]
    v_and_b32 v9, s81, v36
    v_lshlrev_b32 v10, 16, v37
    v_and_b32 v11, s81, v37
    v_fmac_f32 v8, v200, v56
    v_fmac_f32 v9, v201, v57
    v_mfma_f32_16x16x32_bf16 v[68:71], a[124:127], a[152:155], v[68:71]
    s_add_u32 s24, s23, 49152
    v_fmac_f32 v10, v202, v58
    v_fmac_f32 v11, v203, v59
    v_mfma_f32_16x16x32_bf16 v[76:79], a[124:127], a[156:159], v[76:79]
    v_cvt_pk_bf16_f32 v36, v8, v9
    v_cvt_pk_bf16_f32 v37, v10, v11
    v_lshlrev_b32 v8, 16, v38
    v_mfma_f32_16x16x32_bf16 v[80:83], a[64:67], a[160:163], v[16:19]
    ds_read_b128 v[44:47], v2 offset:16832
    s_waitcnt lgkmcnt(4)
    buffer_store_dwordx4 a[216:219], v12, s[12:15], s24 offen offset:0
    s_add_u32 s24, s23, 57344
    v_and_b32 v9, s81, v38
    v_mfma_f32_16x16x32_bf16 v[88:91], a[64:67], a[164:167], v[16:19]
    v_lshlrev_b32 v10, 16, v39
    v_and_b32 v11, s81, v39
    v_fmac_f32 v8, v204, v60
    v_fmac_f32 v9, v205, v61
    v_mfma_f32_16x16x32_bf16 v[84:87], a[68:71], a[160:163], v[20:23]
    s_waitcnt lgkmcnt(3)
    buffer_store_dwordx4 a[220:223], v12, s[12:15], s24 offen offset:0
    v_fmac_f32 v10, v206, v62
    v_fmac_f32 v11, v207, v63
    v_mfma_f32_16x16x32_bf16 v[92:95], a[68:71], a[164:167], v[20:23]
    v_cvt_pk_bf16_f32 v38, v8, v9
    v_cvt_pk_bf16_f32 v39, v10, v11
    v_mfma_f32_16x16x32_bf16 v[80:83], a[72:75], a[168:171], v[80:83]
    ds_write_b128 v2, v[36:39] offset:16768
    s_waitcnt lgkmcnt(3)
    v_lshlrev_b32 v8, 16, v40
    v_and_b32 v9, s81, v40
    v_lshlrev_b32 v10, 16, v41
    v_mfma_f32_16x16x32_bf16 v[88:91], a[72:75], a[172:175], v[88:91]
    v_and_b32 v11, s81, v41
    v_fmac_f32 v8, v224, v64
    v_fmac_f32 v9, v225, v65
    v_mfma_f32_16x16x32_bf16 v[84:87], a[76:79], a[168:171], v[84:87]
    v_fmac_f32 v10, v226, v66
    v_fmac_f32 v11, v227, v67
    v_cvt_pk_bf16_f32 v40, v8, v9
    v_mfma_f32_16x16x32_bf16 v[92:95], a[76:79], a[172:175], v[92:95]
    v_cvt_pk_bf16_f32 v41, v10, v11
    v_lshlrev_b32 v8, 16, v42
    v_mfma_f32_16x16x32_bf16 v[80:83], a[80:83], a[176:179], v[80:83]
    v_and_b32 v9, s81, v42
    v_lshlrev_b32 v10, 16, v43
    v_and_b32 v11, s81, v43
    v_mfma_f32_16x16x32_bf16 v[88:91], a[80:83], a[180:183], v[88:91]
    v_fmac_f32 v8, v228, v68
    v_fmac_f32 v9, v229, v69
    v_mfma_f32_16x16x32_bf16 v[84:87], a[84:87], a[176:179], v[84:87]
    v_fmac_f32 v10, v230, v70
    v_fmac_f32 v11, v231, v71
    v_mfma_f32_16x16x32_bf16 v[92:95], a[84:87], a[180:183], v[92:95]
    v_cvt_pk_bf16_f32 v42, v8, v9
    v_cvt_pk_bf16_f32 v43, v10, v11
    v_mfma_f32_16x16x32_bf16 v[80:83], a[88:91], a[184:187], v[80:83]
    ds_read_b128 v[32:35], v2 offset:33408
    ds_write_b128 v2, v[40:43] offset:192
    s_waitcnt lgkmcnt(3)
    v_lshlrev_b32 v8, 16, v44
    v_and_b32 v9, s81, v44
    v_mfma_f32_16x16x32_bf16 v[88:91], a[88:91], a[188:191], v[88:91]
    v_lshlrev_b32 v10, 16, v45
    v_and_b32 v11, s81, v45
    v_fmac_f32 v8, v232, v72
    v_fmac_f32 v9, v233, v73
    v_mfma_f32_16x16x32_bf16 v[84:87], a[92:95], a[184:187], v[84:87]
    v_fmac_f32 v10, v234, v74
    v_fmac_f32 v11, v235, v75
    v_cvt_pk_bf16_f32 v44, v8, v9
    v_mfma_f32_16x16x32_bf16 v[92:95], a[92:95], a[188:191], v[92:95]
    v_cvt_pk_bf16_f32 v45, v10, v11
    v_lshlrev_b32 v8, 16, v46
    v_mfma_f32_16x16x32_bf16 v[96:99], a[96:99], a[160:163], v[24:27]
    ds_read_b128 v[36:39], v2 offset:50048
    v_and_b32 v9, s81, v46
    v_lshlrev_b32 v10, 16, v47
    v_mfma_f32_16x16x32_bf16 v[104:107], a[96:99], a[164:167], v[24:27]
    v_and_b32 v11, s81, v47
    v_fmac_f32 v8, v236, v76
    v_fmac_f32 v9, v237, v77
    v_mfma_f32_16x16x32_bf16 v[100:103], a[100:103], a[160:163], v[28:31]
    v_fmac_f32 v10, v238, v78
    v_fmac_f32 v11, v239, v79
    v_mfma_f32_16x16x32_bf16 v[108:111], a[100:103], a[164:167], v[28:31]
    v_cvt_pk_bf16_f32 v46, v8, v9
    v_cvt_pk_bf16_f32 v47, v10, v11
    v_mfma_f32_16x16x32_bf16 v[96:99], a[104:107], a[168:171], v[96:99]
    ds_write_b128 v2, v[44:47] offset:16832
    v_mfma_f32_16x16x32_bf16 v[104:107], a[104:107], a[172:175], v[104:107]
    v_mfma_f32_16x16x32_bf16 v[100:103], a[108:111], a[168:171], v[100:103]
    v_mfma_f32_16x16x32_bf16 v[108:111], a[108:111], a[172:175], v[108:111]
    v_mfma_f32_16x16x32_bf16 v[96:99], a[112:115], a[176:179], v[96:99]
    v_mfma_f32_16x16x32_bf16 v[104:107], a[112:115], a[180:183], v[104:107]
    v_mfma_f32_16x16x32_bf16 v[100:103], a[116:119], a[176:179], v[100:103]
    ds_read_b128 v[40:43], v2 offset:33472
    v_mfma_f32_16x16x32_bf16 v[108:111], a[116:119], a[180:183], v[108:111]
    v_mfma_f32_16x16x32_bf16 v[96:99], a[120:123], a[184:187], v[96:99]
    ds_read_b128 v[44:47], v2 offset:50112
    v_mfma_f32_16x16x32_bf16 v[104:107], a[120:123], a[188:191], v[104:107]
    v_mfma_f32_16x16x32_bf16 v[100:103], a[124:127], a[184:187], v[100:103]
    v_mfma_f32_16x16x32_bf16 v[108:111], a[124:127], a[188:191], v[108:111]
    ds_read_b128 a[224:227], v7 offset:128
    ds_read_b128 a[228:231], v7 offset:8448
    ds_read_b128 a[232:235], v7 offset:16768
    ds_read_b128 a[236:239], v7 offset:25088
    s_add_u32 s24, s23, 0
    s_waitcnt lgkmcnt(3)
    buffer_store_dwordx4 a[224:227], v12, s[12:15], s24 offen offset:128
    s_add_u32 s24, s23, 8192
    s_waitcnt lgkmcnt(2)
    buffer_store_dwordx4 a[228:231], v12, s[12:15], s24 offen offset:128
    s_add_u32 s24, s23, 16384
    s_waitcnt lgkmcnt(1)
    buffer_store_dwordx4 a[232:235], v12, s[12:15], s24 offen offset:128
    s_add_u32 s24, s23, 24576
    s_waitcnt lgkmcnt(0)
    buffer_store_dwordx4 a[236:239], v12, s[12:15], s24 offen offset:128
    v_lshlrev_b32 v8, 16, v32
    v_and_b32 v9, s81, v32
    v_lshlrev_b32 v10, 16, v33
    v_and_b32 v11, s81, v33
    v_fmac_f32 v8, v208, v80
    v_fmac_f32 v9, v209, v81
    v_fmac_f32 v10, v210, v82
    v_fmac_f32 v11, v211, v83
    v_cvt_pk_bf16_f32 v32, v8, v9
    v_cvt_pk_bf16_f32 v33, v10, v11
    v_lshlrev_b32 v8, 16, v34
    v_and_b32 v9, s81, v34
    v_lshlrev_b32 v10, 16, v35
    v_and_b32 v11, s81, v35
    v_fmac_f32 v8, v212, v84
    v_fmac_f32 v9, v213, v85
    v_fmac_f32 v10, v214, v86
    v_fmac_f32 v11, v215, v87
    v_cvt_pk_bf16_f32 v34, v8, v9
    v_cvt_pk_bf16_f32 v35, v10, v11
    ds_write_b128 v2, v[32:35] offset:33408
    v_lshlrev_b32 v8, 16, v36
    v_and_b32 v9, s81, v36
    v_lshlrev_b32 v10, 16, v37
    v_and_b32 v11, s81, v37
    v_fmac_f32 v8, v216, v88
    v_fmac_f32 v9, v217, v89
    v_fmac_f32 v10, v218, v90
    v_fmac_f32 v11, v219, v91
    v_cvt_pk_bf16_f32 v36, v8, v9
    v_cvt_pk_bf16_f32 v37, v10, v11
    v_lshlrev_b32 v8, 16, v38
    v_and_b32 v9, s81, v38
    v_lshlrev_b32 v10, 16, v39
    v_and_b32 v11, s81, v39
    v_fmac_f32 v8, v220, v92
    v_fmac_f32 v9, v221, v93
    v_fmac_f32 v10, v222, v94
    v_fmac_f32 v11, v223, v95
    v_cvt_pk_bf16_f32 v38, v8, v9
    v_cvt_pk_bf16_f32 v39, v10, v11
    ds_write_b128 v2, v[36:39] offset:50048
    v_lshlrev_b32 v8, 16, v40
    v_and_b32 v9, s81, v40
    v_lshlrev_b32 v10, 16, v41
    v_and_b32 v11, s81, v41
    v_fmac_f32 v8, v240, v96
    v_fmac_f32 v9, v241, v97
    v_fmac_f32 v10, v242, v98
    v_fmac_f32 v11, v243, v99
    v_cvt_pk_bf16_f32 v40, v8, v9
    v_cvt_pk_bf16_f32 v41, v10, v11
    v_lshlrev_b32 v8, 16, v42
    v_and_b32 v9, s81, v42
    v_lshlrev_b32 v10, 16, v43
    v_and_b32 v11, s81, v43
    v_fmac_f32 v8, v244, v100
    v_fmac_f32 v9, v245, v101
    v_fmac_f32 v10, v246, v102
    v_fmac_f32 v11, v247, v103
    v_cvt_pk_bf16_f32 v42, v8, v9
    v_cvt_pk_bf16_f32 v43, v10, v11
    ds_write_b128 v2, v[40:43] offset:33472
    v_lshlrev_b32 v8, 16, v44
    v_and_b32 v9, s81, v44
    v_lshlrev_b32 v10, 16, v45
    v_and_b32 v11, s81, v45
    v_fmac_f32 v8, v248, v104
    v_fmac_f32 v9, v249, v105
    v_fmac_f32 v10, v250, v106
    v_fmac_f32 v11, v251, v107
    v_cvt_pk_bf16_f32 v44, v8, v9
    v_cvt_pk_bf16_f32 v45, v10, v11
    v_lshlrev_b32 v8, 16, v46
    v_and_b32 v9, s81, v46
    v_lshlrev_b32 v10, 16, v47
    v_and_b32 v11, s81, v47
    v_fmac_f32 v8, v252, v108
    v_fmac_f32 v9, v253, v109
    v_fmac_f32 v10, v254, v110
    v_fmac_f32 v11, v255, v111
    v_cvt_pk_bf16_f32 v46, v8, v9
    v_cvt_pk_bf16_f32 v47, v10, v11
    ds_write_b128 v2, v[44:47] offset:50112
    ds_read_b128 a[240:243], v7 offset:33408
    ds_read_b128 a[244:247], v7 offset:41728
    ds_read_b128 a[248:251], v7 offset:50048
    ds_read_b128 a[252:255], v7 offset:58368
    s_add_u32 s24, s23, 32768
    s_waitcnt lgkmcnt(3)
    buffer_store_dwordx4 a[240:243], v12, s[12:15], s24 offen offset:128
    s_add_u32 s24, s23, 40960
    s_waitcnt lgkmcnt(2)
    buffer_store_dwordx4 a[244:247], v12, s[12:15], s24 offen offset:128
    s_add_u32 s24, s23, 49152
    s_waitcnt lgkmcnt(1)
    buffer_store_dwordx4 a[248:251], v12, s[12:15], s24 offen offset:128
    s_add_u32 s24, s23, 57344
    s_waitcnt lgkmcnt(0)
    buffer_store_dwordx4 a[252:255], v12, s[12:15], s24 offen offset:128
L_done:
    s_endpgm
L_Nend:
    ds_read_b64 v[14:15], v0 offset:0
    s_waitcnt lgkmcnt(0)
    v_xor_b32 v14, s80, v14
    v_xor_b32 v15, s80, v15
    v_or_b32 v14, v14, v15
    v_cmp_ne_u32 s[62:63], 0, v14
    ds_read_b64 v[14:15], v0 offset:8
    s_waitcnt lgkmcnt(0)
    v_xor_b32 v14, s80, v14
    v_xor_b32 v15, s80, v15
    v_or_b32 v14, v14, v15
    v_cmp_ne_u32 vcc, 0, v14
    s_nop 4
    s_or_b64 vcc, vcc, s[62:63]
    s_cbranch_scc0 L_B3
    s_mov_b32 m0, s58
    s_nop 0
    buffer_load_dword v13, s[8:11], 0 offen sc0 sc1 lds
    s_waitcnt vmcnt(0)
    ds_read_b64 v[14:15], v0 offset:0
    s_waitcnt lgkmcnt(0)
    v_xor_b32 v14, s80, v14
    v_xor_b32 v15, s80, v15
    v_or_b32 v14, v14, v15
    v_cmp_ne_u32 s[62:63], 0, v14
    ds_read_b64 v[14:15], v0 offset:8
    s_waitcnt lgkmcnt(0)
    v_xor_b32 v14, s80, v14
    v_xor_b32 v15, s80, v15
    v_or_b32 v14, v14, v15
    v_cmp_ne_u32 vcc, 0, v14
    s_nop 4
    s_or_b64 vcc, vcc, s[62:63]
    s_cbranch_scc0 L_B3
    s_mov_b32 m0, s58
    s_nop 0
    buffer_load_dword v13, s[8:11], 0 offen sc0 sc1 lds
    s_waitcnt vmcnt(0)
    ds_read_b64 v[14:15], v0 offset:0
    s_waitcnt lgkmcnt(0)
    v_xor_b32 v14, s80, v14
    v_xor_b32 v15, s80, v15
    v_or_b32 v14, v14, v15
    v_cmp_ne_u32 s[62:63], 0, v14
    ds_read_b64 v[14:15], v0 offset:8
    s_waitcnt lgkmcnt(0)
    v_xor_b32 v14, s80, v14
    v_xor_b32 v15, s80, v15
    v_or_b32 v14, v14, v15
    v_cmp_ne_u32 vcc, 0, v14
    s_nop 4
    s_or_b64 vcc, vcc, s[62:63]
    s_cbranch_scc0 L_B3
    s_mov_b32 m0, s58
    s_nop 0
    buffer_load_dword v13, s[8:11], 0 offen sc0 sc1 lds
    s_waitcnt vmcnt(0)
    ds_read_b64 v[14:15], v0 offset:0
    s_waitcnt lgkmcnt(0)
    v_xor_b32 v14, s80, v14
    v_xor_b32 v15, s80, v15
    v_or_b32 v14, v14, v15
    v_cmp_ne_u32 s[62:63], 0, v14
    ds_read_b64 v[14:15], v0 offset:8
    s_waitcnt lgkmcnt(0)
    v_xor_b32 v14, s80, v14
    v_xor_b32 v15, s80, v15
    v_or_b32 v14, v14, v15
    v_cmp_ne_u32 vcc, 0, v14
    s_nop 4
    s_or_b64 vcc, vcc, s[62:63]
    s_cbranch_scc0 L_B3
    s_mov_b32 m0, s58
    s_nop 0
    buffer_load_dword v13, s[8:11], 0 offen sc0 sc1 lds
    s_waitcnt vmcnt(0)
    ds_read_b64 v[14:15], v0 offset:0
    s_waitcnt lgkmcnt(0)
    v_xor_b32 v14, s80, v14
    v_xor_b32 v15, s80, v15
    v_or_b32 v14, v14, v15
    v_cmp_ne_u32 s[62:63], 0, v14
    ds_read_b64 v[14:15], v0 offset:8
    s_waitcnt lgkmcnt(0)
    v_xor_b32 v14, s80, v14
    v_xor_b32 v15, s80, v15
    v_or_b32 v14, v14, v15
    v_cmp_ne_u32 vcc, 0, v14
    s_nop 4
    s_or_b64 vcc, vcc, s[62:63]
    s_cbranch_scc0 L_B3
    s_mov_b32 m0, s58
    s_nop 0
    buffer_load_dword v13, s[8:11], 0 offen sc0 sc1 lds
    s_waitcnt vmcnt(0)
    ds_read_b64 v[14:15], v0 offset:0
    s_waitcnt lgkmcnt(0)
    v_xor_b32 v14, s80, v14
    v_xor_b32 v15, s80, v15
    v_or_b32 v14, v14, v15
    v_cmp_ne_u32 s[62:63], 0, v14
    ds_read_b64 v[14:15], v0 offset:8
    s_waitcnt lgkmcnt(0)
    v_xor_b32 v14, s80, v14
    v_xor_b32 v15, s80, v15
    v_or_b32 v14, v14, v15
    v_cmp_ne_u32 vcc, 0, v14
    s_nop 4
    s_or_b64 vcc, vcc, s[62:63]
    s_cbranch_scc0 L_B3
    s_mov_b32 m0, s58
    s_nop 0
    buffer_load_dword v13, s[8:11], 0 offen sc0 sc1 lds
    s_waitcnt vmcnt(0)
    ds_read_b64 v[14:15], v0 offset:0
    s_waitcnt lgkmcnt(0)
    v_xor_b32 v14, s80, v14
    v_xor_b32 v15, s80, v15
    v_or_b32 v14, v14, v15
    v_cmp_ne_u32 s[62:63], 0, v14
    ds_read_b64 v[14:15], v0 offset:8
    s_waitcnt lgkmcnt(0)
    v_xor_b32 v14, s80, v14
    v_xor_b32 v15, s80, v15
    v_or_b32 v14, v14, v15
    v_cmp_ne_u32 vcc, 0, v14
    s_nop 4
    s_or_b64 vcc, vcc, s[62:63]
    s_cbranch_scc0 L_B3
    s_mov_b32 m0, s58
    s_nop 0
    buffer_load_dword v13, s[8:11], 0 offen sc0 sc1 lds
    s_waitcnt vmcnt(0)
    ds_read_b64 v[14:15], v0 offset:0
    s_waitcnt lgkmcnt(0)
    v_xor_b32 v14, s80, v14
    v_xor_b32 v15, s80, v15
    v_or_b32 v14, v14, v15
    v_cmp_ne_u32 s[62:63], 0, v14
    ds_read_b64 v[14:15], v0 offset:8
    s_waitcnt lgkmcnt(0)
    v_xor_b32 v14, s80, v14
    v_xor_b32 v15, s80, v15
    v_or_b32 v14, v14, v15
    v_cmp_ne_u32 vcc, 0, v14
    s_nop 4
    s_or_b64 vcc, vcc, s[62:63]
    s_cbranch_scc0 L_B3
    s_mov_b32 m0, s58
    s_nop 0
    buffer_load_dword v13, s[8:11], 0 offen sc0 sc1 lds
    s_waitcnt vmcnt(0)
    ds_read_b64 v[14:15], v0 offset:0
    s_waitcnt lgkmcnt(0)
    v_xor_b32 v14, s80, v14
    v_xor_b32 v15, s80, v15
    v_or_b32 v14, v14, v15
    v_cmp_ne_u32 s[62:63], 0, v14
    ds_read_b64 v[14:15], v0 offset:8
    s_waitcnt lgkmcnt(0)
    v_xor_b32 v14, s80, v14
    v_xor_b32 v15, s80, v15
    v_or_b32 v14, v14, v15
    v_cmp_ne_u32 vcc, 0, v14
    s_nop 4
    s_or_b64 vcc, vcc, s[62:63]
    s_cbranch_scc0 L_B3
    s_mov_b32 m0, s58
    s_nop 0
    buffer_load_dword v13, s[8:11], 0 offen sc0 sc1 lds
    s_waitcnt vmcnt(0)
    ds_read_b64 v[14:15], v0 offset:0
    s_waitcnt lgkmcnt(0)
    v_xor_b32 v14, s80, v14
    v_xor_b32 v15, s80, v15
    v_or_b32 v14, v14, v15
    v_cmp_ne_u32 s[62:63], 0, v14
    ds_read_b64 v[14:15], v0 offset:8
    s_waitcnt lgkmcnt(0)
    v_xor_b32 v14, s80, v14
    v_xor_b32 v15, s80, v15
    v_or_b32 v14, v14, v15
    v_cmp_ne_u32 vcc, 0, v14
    s_nop 4
    s_or_b64 vcc, vcc, s[62:63]
    s_cbranch_scc0 L_B3
    s_mov_b32 m0, s58
    s_nop 0
    buffer_load_dword v13, s[8:11], 0 offen sc0 sc1 lds
    s_waitcnt vmcnt(0)
    ds_read_b64 v[14:15], v0 offset:0
    s_waitcnt lgkmcnt(0)
    v_xor_b32 v14, s80, v14
    v_xor_b32 v15, s80, v15
    v_or_b32 v14, v14, v15
    v_cmp_ne_u32 s[62:63], 0, v14
    ds_read_b64 v[14:15], v0 offset:8
    s_waitcnt lgkmcnt(0)
    v_xor_b32 v14, s80, v14
    v_xor_b32 v15, s80, v15
    v_or_b32 v14, v14, v15
    v_cmp_ne_u32 vcc, 0, v14
    s_nop 4
    s_or_b64 vcc, vcc, s[62:63]
    s_cbranch_scc0 L_B3
    s_mov_b32 m0, s58
    s_nop 0
    buffer_load_dword v13, s[8:11], 0 offen sc0 sc1 lds
    s_waitcnt vmcnt(0)
    ds_read_b64 v[14:15], v0 offset:0
    s_waitcnt lgkmcnt(0)
    v_xor_b32 v14, s80, v14
    v_xor_b32 v15, s80, v15
    v_or_b32 v14, v14, v15
    v_cmp_ne_u32 s[62:63], 0, v14
    ds_read_b64 v[14:15], v0 offset:8
    s_waitcnt lgkmcnt(0)
    v_xor_b32 v14, s80, v14
    v_xor_b32 v15, s80, v15
    v_or_b32 v14, v14, v15
    v_cmp_ne_u32 vcc, 0, v14
    s_nop 4
    s_or_b64 vcc, vcc, s[62:63]
    s_cbranch_scc0 L_B3
    s_mov_b32 m0, s58
    s_nop 0
    buffer_load_dword v13, s[8:11], 0 offen sc0 sc1 lds
    s_waitcnt vmcnt(0)
    ds_read_b64 v[14:15], v0 offset:0
    s_waitcnt lgkmcnt(0)
    v_xor_b32 v14, s80, v14
    v_xor_b32 v15, s80, v15
    v_or_b32 v14, v14, v15
    v_cmp_ne_u32 s[62:63], 0, v14
    ds_read_b64 v[14:15], v0 offset:8
    s_waitcnt lgkmcnt(0)
    v_xor_b32 v14, s80, v14
    v_xor_b32 v15, s80, v15
    v_or_b32 v14, v14, v15
    v_cmp_ne_u32 vcc, 0, v14
    s_nop 4
    s_or_b64 vcc, vcc, s[62:63]
    s_cbranch_scc0 L_B3
    s_mov_b32 m0, s58
    s_nop 0
    buffer_load_dword v13, s[8:11], 0 offen sc0 sc1 lds
    s_waitcnt vmcnt(0)
    ds_read_b64 v[14:15], v0 offset:0
    s_waitcnt lgkmcnt(0)
    v_xor_b32 v14, s80, v14
    v_xor_b32 v15, s80, v15
    v_or_b32 v14, v14, v15
    v_cmp_ne_u32 s[62:63], 0, v14
    ds_read_b64 v[14:15], v0 offset:8
    s_waitcnt lgkmcnt(0)
    v_xor_b32 v14, s80, v14
    v_xor_b32 v15, s80, v15
    v_or_b32 v14, v14, v15
    v_cmp_ne_u32 vcc, 0, v14
    s_nop 4
    s_or_b64 vcc, vcc, s[62:63]
    s_cbranch_scc0 L_B3
    s_mov_b32 m0, s58
    s_nop 0
    buffer_load_dword v13, s[8:11], 0 offen sc0 sc1 lds
    s_waitcnt vmcnt(0)
    ds_read_b64 v[14:15], v0 offset:0
    s_waitcnt lgkmcnt(0)
    v_xor_b32 v14, s80, v14
    v_xor_b32 v15, s80, v15
    v_or_b32 v14, v14, v15
    v_cmp_ne_u32 s[62:63], 0, v14
    ds_read_b64 v[14:15], v0 offset:8
    s_waitcnt lgkmcnt(0)
    v_xor_b32 v14, s80, v14
    v_xor_b32 v15, s80, v15
    v_or_b32 v14, v14, v15
    v_cmp_ne_u32 vcc, 0, v14
    s_nop 4
    s_or_b64 vcc, vcc, s[62:63]
    s_cbranch_scc0 L_B3
    s_mov_b32 m0, s58
    s_nop 0
    buffer_load_dword v13, s[8:11], 0 offen sc0 sc1 lds
    s_waitcnt vmcnt(0)
    ds_read_b64 v[14:15], v0 offset:0
    s_waitcnt lgkmcnt(0)
    v_xor_b32 v14, s80, v14
    v_xor_b32 v15, s80, v15
    v_or_b32 v14, v14, v15
    v_cmp_ne_u32 s[62:63], 0, v14
    ds_read_b64 v[14:15], v0 offset:8
    s_waitcnt lgkmcnt(0)
    v_xor_b32 v14, s80, v14
    v_xor_b32 v15, s80, v15
    v_or_b32 v14, v14, v15
    v_cmp_ne_u32 vcc, 0, v14
    s_nop 4
    s_or_b64 vcc, vcc, s[62:63]
    s_cbranch_scc0 L_B3
    s_mov_b32 m0, s58
    s_nop 0
    buffer_load_dword v13, s[8:11], 0 offen sc0 sc1 lds
    s_waitcnt vmcnt(0)
    ds_read_b64 v[14:15], v0 offset:0
    s_waitcnt lgkmcnt(0)
    v_xor_b32 v14, s80, v14
    v_xor_b32 v15, s80, v15
    v_or_b32 v14, v14, v15
    v_cmp_ne_u32 s[62:63], 0, v14
    ds_read_b64 v[14:15], v0 offset:8
    s_waitcnt lgkmcnt(0)
    v_xor_b32 v14, s80, v14
    v_xor_b32 v15, s80, v15
    v_or_b32 v14, v14, v15
    v_cmp_ne_u32 vcc, 0, v14
    s_nop 4
    s_or_b64 vcc, vcc, s[62:63]
    s_cbranch_scc0 L_B3
    s_mov_b32 m0, s58
    s_nop 0
    buffer_load_dword v13, s[8:11], 0 offen sc0 sc1 lds
    s_waitcnt vmcnt(0)
    ds_read_b64 v[14:15], v0 offset:0
    s_waitcnt lgkmcnt(0)
    v_xor_b32 v14, s80, v14
    v_xor_b32 v15, s80, v15
    v_or_b32 v14, v14, v15
    v_cmp_ne_u32 s[62:63], 0, v14
    ds_read_b64 v[14:15], v0 offset:8
    s_waitcnt lgkmcnt(0)
    v_xor_b32 v14, s80, v14
    v_xor_b32 v15, s80, v15
    v_or_b32 v14, v14, v15
    v_cmp_ne_u32 vcc, 0, v14
    s_nop 4
    s_or_b64 vcc, vcc, s[62:63]
    s_cbranch_scc0 L_B3
    s_mov_b32 m0, s58
    s_nop 0
    buffer_load_dword v13, s[8:11], 0 offen sc0 sc1 lds
    s_waitcnt vmcnt(0)
    ds_read_b64 v[14:15], v0 offset:0
    s_waitcnt lgkmcnt(0)
    v_xor_b32 v14, s80, v14
    v_xor_b32 v15, s80, v15
    v_or_b32 v14, v14, v15
    v_cmp_ne_u32 s[62:63], 0, v14
    ds_read_b64 v[14:15], v0 offset:8
    s_waitcnt lgkmcnt(0)
    v_xor_b32 v14, s80, v14
    v_xor_b32 v15, s80, v15
    v_or_b32 v14, v14, v15
    v_cmp_ne_u32 vcc, 0, v14
    s_nop 4
    s_or_b64 vcc, vcc, s[62:63]
    s_cbranch_scc0 L_B3
    s_mov_b32 m0, s58
    s_nop 0
    buffer_load_dword v13, s[8:11], 0 offen sc0 sc1 lds
    s_waitcnt vmcnt(0)
    ds_read_b64 v[14:15], v0 offset:0
    s_waitcnt lgkmcnt(0)
    v_xor_b32 v14, s80, v14
    v_xor_b32 v15, s80, v15
    v_or_b32 v14, v14, v15
    v_cmp_ne_u32 s[62:63], 0, v14
    ds_read_b64 v[14:15], v0 offset:8
    s_waitcnt lgkmcnt(0)
    v_xor_b32 v14, s80, v14
    v_xor_b32 v15, s80, v15
    v_or_b32 v14, v14, v15
    v_cmp_ne_u32 vcc, 0, v14
    s_nop 4
    s_or_b64 vcc, vcc, s[62:63]
    s_cbranch_scc0 L_B3
    s_mov_b32 m0, s58
    s_nop 0
    buffer_load_dword v13, s[8:11], 0 offen sc0 sc1 lds
    s_waitcnt vmcnt(0)
    ds_read_b64 v[14:15], v0 offset:0
    s_waitcnt lgkmcnt(0)
    v_xor_b32 v14, s80, v14
    v_xor_b32 v15, s80, v15
    v_or_b32 v14, v14, v15
    v_cmp_ne_u32 s[62:63], 0, v14
    ds_read_b64 v[14:15], v0 offset:8
    s_waitcnt lgkmcnt(0)
    v_xor_b32 v14, s80, v14
    v_xor_b32 v15, s80, v15
    v_or_b32 v14, v14, v15
    v_cmp_ne_u32 vcc, 0, v14
    s_nop 4
    s_or_b64 vcc, vcc, s[62:63]
    s_cbranch_scc0 L_B3
    s_mov_b32 m0, s58
    s_nop 0
    buffer_load_dword v13, s[8:11], 0 offen sc0 sc1 lds
    s_waitcnt vmcnt(0)
    ds_read_b64 v[14:15], v0 offset:0
    s_waitcnt lgkmcnt(0)
    v_xor_b32 v14, s80, v14
    v_xor_b32 v15, s80, v15
    v_or_b32 v14, v14, v15
    v_cmp_ne_u32 s[62:63], 0, v14
    ds_read_b64 v[14:15], v0 offset:8
    s_waitcnt lgkmcnt(0)
    v_xor_b32 v14, s80, v14
    v_xor_b32 v15, s80, v15
    v_or_b32 v14, v14, v15
    v_cmp_ne_u32 vcc, 0, v14
    s_nop 4
    s_or_b64 vcc, vcc, s[62:63]
    s_cbranch_scc0 L_B3
    s_mov_b32 m0, s58
    s_nop 0
    buffer_load_dword v13, s[8:11], 0 offen sc0 sc1 lds
    s_waitcnt vmcnt(0)
    ds_read_b64 v[14:15], v0 offset:0
    s_waitcnt lgkmcnt(0)
    v_xor_b32 v14, s80, v14
    v_xor_b32 v15, s80, v15
    v_or_b32 v14, v14, v15
    v_cmp_ne_u32 s[62:63], 0, v14
    ds_read_b64 v[14:15], v0 offset:8
    s_waitcnt lgkmcnt(0)
    v_xor_b32 v14, s80, v14
    v_xor_b32 v15, s80, v15
    v_or_b32 v14, v14, v15
    v_cmp_ne_u32 vcc, 0, v14
    s_nop 4
    s_or_b64 vcc, vcc, s[62:63]
    s_cbranch_scc0 L_B3
    s_mov_b32 m0, s58
    s_nop 0
    buffer_load_dword v13, s[8:11], 0 offen sc0 sc1 lds
    s_waitcnt vmcnt(0)
    ds_read_b64 v[14:15], v0 offset:0
    s_waitcnt lgkmcnt(0)
    v_xor_b32 v14, s80, v14
    v_xor_b32 v15, s80, v15
    v_or_b32 v14, v14, v15
    v_cmp_ne_u32 s[62:63], 0, v14
    ds_read_b64 v[14:15], v0 offset:8
    s_waitcnt lgkmcnt(0)
    v_xor_b32 v14, s80, v14
    v_xor_b32 v15, s80, v15
    v_or_b32 v14, v14, v15
    v_cmp_ne_u32 vcc, 0, v14
    s_nop 4
    s_or_b64 vcc, vcc, s[62:63]
    s_cbranch_scc0 L_B3
    s_mov_b32 m0, s58
    s_nop 0
    buffer_load_dword v13, s[8:11], 0 offen sc0 sc1 lds
    s_waitcnt vmcnt(0)
    ds_read_b64 v[14:15], v0 offset:0
    s_waitcnt lgkmcnt(0)
    v_xor_b32 v14, s80, v14
    v_xor_b32 v15, s80, v15
    v_or_b32 v14, v14, v15
    v_cmp_ne_u32 s[62:63], 0, v14
    ds_read_b64 v[14:15], v0 offset:8
    s_waitcnt lgkmcnt(0)
    v_xor_b32 v14, s80, v14
    v_xor_b32 v15, s80, v15
    v_or_b32 v14, v14, v15
    v_cmp_ne_u32 vcc, 0, v14
    s_nop 4
    s_or_b64 vcc, vcc, s[62:63]
    s_cbranch_scc0 L_B3
    s_add_u32 s57, s56, 0
    buffer_load_dwordx4 a[0:3], v12, s[44:47], s57 offen offset:0
    s_add_u32 s57, s56, 0
    buffer_load_dwordx4 a[4:7], v12, s[44:47], s57 offen offset:1024
    s_mov_b32 m0, s58
    s_nop 0
    buffer_load_dword v13, s[8:11], 0 offen sc0 sc1 lds
    s_add_u32 s57, s56, 0
    buffer_load_dwordx4 a[8:11], v12, s[44:47], s57 offen offset:16
    s_add_u32 s57, s56, 0
    buffer_load_dwordx4 a[12:15], v12, s[44:47], s57 offen offset:1040
    s_add_u32 s57, s56, 0
    buffer_load_dwordx4 a[16:19], v12, s[44:47], s57 offen offset:32
    s_add_u32 s57, s56, 0
    buffer_load_dwordx4 a[20:23], v12, s[44:47], s57 offen offset:1056
    s_mov_b32 m0, s58
    s_nop 0
    buffer_load_dword v13, s[8:11], 0 offen sc0 sc1 lds
    s_add_u32 s57, s56, 0
    buffer_load_dwordx4 a[24:27], v12, s[44:47], s57 offen offset:48
    s_add_u32 s57, s56, 0
    buffer_load_dwordx4 a[28:31], v12, s[44:47], s57 offen offset:1072
    s_add_u32 s21, s21, 8192
    s_add_u32 s57, s56, 8192
    buffer_load_dwordx4 a[32:35], v12, s[44:47], s57 offen offset:0
    s_add_u32 s57, s56, 8192
    buffer_load_dwordx4 a[36:39], v12, s[44:47], s57 offen offset:1024
    s_mov_b32 m0, s58
    s_nop 0
    buffer_load_dword v13, s[8:11], 0 offen sc0 sc1 lds
    s_add_u32 s57, s56, 8192
    buffer_load_dwordx4 a[40:43], v12, s[44:47], s57 offen offset:16
    s_add_u32 s57, s56, 8192
    buffer_load_dwordx4 a[44:47], v12, s[44:47], s57 offen offset:1040
    s_add_u32 s57, s56, 8192
    buffer_load_dwordx4 a[48:51], v12, s[44:47], s57 offen offset:32
    s_add_u32 s57, s56, 8192
    buffer_load_dwordx4 a[52:55], v12, s[44:47], s57 offen offset:1056
    s_mov_b32 m0, s58
    s_nop 0
    buffer_load_dword v13, s[8:11], 0 offen sc0 sc1 lds
    s_add_u32 s57, s56, 8192
    buffer_load_dwordx4 a[56:59], v12, s[44:47], s57 offen offset:48
    s_add_u32 s57, s56, 8192
    buffer_load_dwordx4 a[60:63], v12, s[44:47], s57 offen offset:1072
    s_add_u32 s21, s21, 8192
    s_add_u32 s57, s56, 16384
    buffer_load_dwordx4 a[64:67], v12, s[44:47], s57 offen offset:0
    s_add_u32 s57, s56, 16384
    buffer_load_dwordx4 a[68:71], v12, s[44:47], s57 offen offset:1024
    s_mov_b32 m0, s58
    s_nop 0
    buffer_load_dword v13, s[8:11], 0 offen sc0 sc1 lds
    s_add_u32 s57, s56, 16384
    buffer_load_dwordx4 a[72:75], v12, s[44:47], s57 offen offset:16
    s_add_u32 s57, s56, 16384
    buffer_load_dwordx4 a[76:79], v12, s[44:47], s57 offen offset:1040
    s_add_u32 s57, s56, 16384
    buffer_load_dwordx4 a[80:83], v12, s[44:47], s57 offen offset:32
    s_add_u32 s57, s56, 16384
    buffer_load_dwordx4 a[84:87], v12, s[44:47], s57 offen offset:1056
    s_mov_b32 m0, s58
    s_nop 0
    buffer_load_dword v13, s[8:11], 0 offen sc0 sc1 lds
    s_add_u32 s57, s56, 16384
    buffer_load_dwordx4 a[88:91], v12, s[44:47], s57 offen offset:48
    s_add_u32 s57, s56, 16384
    buffer_load_dwordx4 a[92:95], v12, s[44:47], s57 offen offset:1072
    s_add_u32 s21, s21, 8192
    s_branch L_Stop
L_Stop:
    s_waitcnt vmcnt(25) lgkmcnt(7)
    v_mfma_f32_16x16x32_bf16 v[48:51], a[0:3], a[128:131], v[16:19]
    s_waitcnt lgkmcnt(6)
    v_mfma_f32_16x16x32_bf16 v[56:59], a[0:3], a[132:135], v[16:19]
L_S0:
    ds_read_b64 v[14:15], v0 offset:0
    s_waitcnt lgkmcnt(0)
    v_xor_b32 v14, s80, v14
    v_xor_b32 v15, s80, v15
    v_or_b32 v14, v14, v15
    v_cmp_ne_u32 s[62:63], 0, v14
    ds_read_b64 v[14:15], v0 offset:8
    s_waitcnt lgkmcnt(0)
    v_xor_b32 v14, s80, v14
    v_xor_b32 v15, s80, v15
    v_or_b32 v14, v14, v15
    v_cmp_ne_u32 vcc, 0, v14
    s_nop 4
    s_or_b64 vcc, vcc, s[62:63]
    s_cbranch_scc0 L_F0
    s_add_u32 s57, s56, 131072
    buffer_load_dwordx4 a[96:99], v7, s[48:51], s57 offen offset:0
    v_mfma_f32_16x16x32_bf16 v[52:55], a[4:7], a[128:131], v[20:23]
    v_mfma_f32_16x16x32_bf16 v[60:63], a[4:7], a[132:135], v[20:23]
    v_mfma_f32_16x16x32_bf16 v[48:51], a[8:11], a[136:139], v[48:51]
    s_add_u32 s57, s56, 135168
    buffer_load_dwordx4 a[100:103], v7, s[48:51], s57 offen offset:0
    s_mov_b32 m0, s58
    s_nop 0
    buffer_load_dword v13, s[8:11], 0 offen sc0 sc1 lds
    v_mfma_f32_16x16x32_bf16 v[56:59], a[8:11], a[140:143], v[56:59]
    v_cvt_pk_bf16_f32 v112, v112, v113
    v_cvt_pk_bf16_f32 v113, v114, v115
    v_cvt_pk_bf16_f32 v114, v116, v117
    v_cvt_pk_bf16_f32 v115, v118, v119
    v_mfma_f32_16x16x32_bf16 v[52:55], a[12:15], a[136:139], v[52:55]
    ds_write_b128 v4, v[112:115] offset:2560
    v_cvt_pk_bf16_f32 v116, v120, v121
    v_cvt_pk_bf16_f32 v117, v122, v123
    v_mfma_f32_16x16x32_bf16 v[60:63], a[12:15], a[140:143], v[60:63]
    v_cvt_pk_bf16_f32 v118, v124, v125
    v_cvt_pk_bf16_f32 v119, v126, v127
    s_waitcnt vmcnt(23)
    v_mfma_f32_16x16x32_bf16 v[48:51], a[16:19], a[144:147], v[48:51]
    s_add_u32 s57, s56, 131072
    v_mfma_f32_16x16x32_bf16 v[56:59], a[16:19], a[148:151], v[56:59]
    buffer_load_dwordx4 a[104:107], v7, s[48:51], s57 offen offset:16
    v_mfma_f32_16x16x32_bf16 v[52:55], a[20:23], a[144:147], v[52:55]
    ds_read_b128 v[24:27], v5 offset:128
    ds_read_b128 v[28:31], v5 offset:144
    v_mfma_f32_16x16x32_bf16 v[60:63], a[20:23], a[148:151], v[60:63]
    ds_write_b128 v4, v[116:119] offset:3840
    v_mfma_f32_16x16x32_bf16 v[48:51], a[24:27], a[152:155], v[48:51]
    s_add_u32 s57, s56, 135168
    v_mfma_f32_16x16x32_bf16 v[56:59], a[24:27], a[156:159], v[56:59]
    buffer_load_dwordx4 a[108:111], v7, s[48:51], s57 offen offset:16
    v_mfma_f32_16x16x32_bf16 v[52:55], a[28:31], a[152:155], v[52:55]
    s_waitcnt lgkmcnt(0)
    s_barrier
    ds_read_b128 v[32:35], v2 offset:0
    v_mfma_f32_16x16x32_bf16 v[60:63], a[28:31], a[156:159], v[60:63]
    ds_read_b128 v[36:39], v2 offset:16640
    s_waitcnt vmcnt(20)
    v_mfma_f32_16x16x32_bf16 v[64:67], a[32:35], a[128:131], v[24:27]
    ds_read_b128 a[160:163], v3 offset:2560
    ds_read_b128 a[164:167], v3 offset:3840
    v_mfma_f32_16x16x32_bf16 v[72:75], a[32:35], a[132:135], v[24:27]
    s_add_u32 s57, s56, 131072
    buffer_load_dwordx4 a[112:115], v7, s[48:51], s57 offen offset:32
    v_mfma_f32_16x16x32_bf16 v[68:71], a[36:39], a[128:131], v[28:31]
    ds_read_b128 a[168:171], v3 offset:2576
    v_mfma_f32_16x16x32_bf16 v[76:79], a[36:39], a[132:135], v[28:31]
    v_mfma_f32_16x16x32_bf16 v[64:67], a[40:43], a[136:139], v[64:67]
    ds_read_b128 a[172:175], v3 offset:3856
    s_add_u32 s57, s56, 135168
    buffer_load_dwordx4 a[116:119], v7, s[48:51], s57 offen offset:32
    s_mov_b32 m0, s58
    s_nop 0
    buffer_load_dword v13, s[8:11], 0 offen sc0 sc1 lds
    v_mfma_f32_16x16x32_bf16 v[72:75], a[40:43], a[140:143], v[72:75]
    s_waitcnt lgkmcnt(5)
    v_lshlrev_b32 v8, 16, v32
    v_and_b32 v9, s81, v32
    v_lshlrev_b32 v10, 16, v33
    v_and_b32 v11, s81, v33
    v_fmac_f32 v8, v128, v48
    v_mfma_f32_16x16x32_bf16 v[68:71], a[44:47], a[136:139], v[68:71]
    ds_read_b128 a[176:179], v3 offset:2592
    ds_read_b128 a[180:183], v3 offset:3872
    v_fmac_f32 v9, v129, v49
    v_mfma_f32_16x16x32_bf16 v[76:79], a[44:47], a[140:143], v[76:79]
    v_fmac_f32 v10, v130, v50
    v_fmac_f32 v11, v131, v51
    v_cvt_pk_bf16_f32 v32, v8, v9
    s_waitcnt vmcnt(18)
    v_mfma_f32_16x16x32_bf16 v[64:67], a[48:51], a[144:147], v[64:67]
    ds_read_b128 a[184:187], v3 offset:2608
    s_add_u32 s57, s56, 131072
    buffer_load_dwordx4 a[120:123], v7, s[48:51], s57 offen offset:48
    v_cvt_pk_bf16_f32 v33, v10, v11
    v_mfma_f32_16x16x32_bf16 v[72:75], a[48:51], a[148:151], v[72:75]
    v_lshlrev_b32 v8, 16, v34
    v_and_b32 v9, s81, v34
    v_lshlrev_b32 v10, 16, v35
    v_and_b32 v11, s81, v35
    v_mfma_f32_16x16x32_bf16 v[68:71], a[52:55], a[144:147], v[68:71]
    ds_read_b128 a[188:191], v3 offset:3888
    v_fmac_f32 v8, v132, v52
    v_fmac_f32 v9, v133, v53
    v_mfma_f32_16x16x32_bf16 v[76:79], a[52:55], a[148:151], v[76:79]
    v_fmac_f32 v10, v134, v54
    v_fmac_f32 v11, v135, v55
    v_cvt_pk_bf16_f32 v34, v8, v9
    v_mfma_f32_16x16x32_bf16 v[64:67], a[56:59], a[152:155], v[64:67]
    s_add_u32 s57, s56, 135168
    buffer_load_dwordx4 a[124:127], v7, s[48:51], s57 offen offset:48
    s_add_u32 s21, s21, 8192
    v_mfma_f32_16x16x32_bf16 v[72:75], a[56:59], a[156:159], v[72:75]
    v_cvt_pk_bf16_f32 v35, v10, v11
    s_waitcnt lgkmcnt(8)
    v_lshlrev_b32 v8, 16, v36
    v_and_b32 v9, s81, v36
    v_mfma_f32_16x16x32_bf16 v[68:71], a[60:63], a[152:155], v[68:71]
    ds_read_b128 v[40:43], v2 offset:64
    ds_write_b128 v2, v[32:35] offset:0
    v_lshlrev_b32 v10, 16, v37
    v_and_b32 v11, s81, v37
    v_mfma_f32_16x16x32_bf16 v[76:79], a[60:63], a[156:159], v[76:79]
    v_fmac_f32 v8, v136, v56
    v_fmac_f32 v9, v137, v57
    v_fmac_f32 v10, v138, v58
    s_waitcnt lgkmcnt(9)
    v_mfma_f32_16x16x32_bf16 v[80:83], a[0:3], a[160:163], v[16:19]
    s_waitcnt lgkmcnt(8)
    v_mfma_f32_16x16x32_bf16 v[88:91], a[0:3], a[164:167], v[16:19]
L_S1:
    ds_read_b64 v[14:15], v0 offset:0
    s_waitcnt lgkmcnt(0)
    v_xor_b32 v14, s80, v14
    v_xor_b32 v15, s80, v15
    v_or_b32 v14, v14, v15
    v_cmp_ne_u32 s[62:63], 0, v14
    ds_read_b64 v[14:15], v0 offset:8
    s_waitcnt lgkmcnt(0)
    v_xor_b32 v14, s80, v14
    v_xor_b32 v15, s80, v15
    v_or_b32 v14, v14, v15
    v_cmp_ne_u32 vcc, 0, v14
    s_nop 4
    s_or_b64 vcc, vcc, s[62:63]
    s_cbranch_scc0 L_F1
    s_add_u32 s57, s56, 24576
    buffer_load_dwordx4 a[0:3], v12, s[44:47], s57 offen offset:0
    v_fmac_f32 v11, v139, v59
    v_cvt_pk_bf16_f32 v36, v8, v9
    v_cvt_pk_bf16_f32 v37, v10, v11
    v_lshlrev_b32 v8, 16, v38
    v_and_b32 v9, s81, v38
    v_mfma_f32_16x16x32_bf16 v[84:87], a[4:7], a[160:163], v[20:23]
    ds_read_b128 v[44:47], v2 offset:16704
    v_lshlrev_b32 v10, 16, v39
    v_and_b32 v11, s81, v39
    v_mfma_f32_16x16x32_bf16 v[92:95], a[4:7], a[164:167], v[20:23]
    v_fmac_f32 v8, v140, v60
    v_fmac_f32 v9, v141, v61
    v_mfma_f32_16x16x32_bf16 v[80:83], a[8:11], a[168:171], v[80:83]
    s_add_u32 s57, s56, 24576
    buffer_load_dwordx4 a[4:7], v12, s[44:47], s57 offen offset:1024
    s_mov_b32 m0, s58
    s_nop 0
    buffer_load_dword v13, s[8:11], 0 offen sc0 sc1 lds
    v_mfma_f32_16x16x32_bf16 v[88:91], a[8:11], a[172:175], v[88:91]
    v_fmac_f32 v10, v142, v62
    v_fmac_f32 v11, v143, v63
    v_cvt_pk_bf16_f32 v38, v8, v9
    v_cvt_pk_bf16_f32 v39, v10, v11
    v_mfma_f32_16x16x32_bf16 v[84:87], a[12:15], a[168:171], v[84:87]
    ds_read_b128 v[16:19], v5 offset:256
    ds_write_b128 v2, v[36:39] offset:16640
    v_lshlrev_b32 v8, 16, v40
    v_and_b32 v9, s81, v40
    v_mfma_f32_16x16x32_bf16 v[92:95], a[12:15], a[172:175], v[92:95]
    v_lshlrev_b32 v10, 16, v41
    v_and_b32 v11, s81, v41
    v_fmac_f32 v8, v160, v64
    v_mfma_f32_16x16x32_bf16 v[80:83], a[16:19], a[176:179], v[80:83]
    s_add_u32 s57, s56, 24576
    buffer_load_dwordx4 a[8:11], v12, s[44:47], s57 offen offset:16
    v_fmac_f32 v9, v161, v65
    v_mfma_f32_16x16x32_bf16 v[88:91], a[16:19], a[180:183], v[88:91]
    v_fmac_f32 v10, v162, v66
    v_fmac_f32 v11, v163, v67
    v_cvt_pk_bf16_f32 v40, v8, v9
    v_mfma_f32_16x16x32_bf16 v[84:87], a[20:23], a[176:179], v[84:87]
    ds_read_b128 v[20:23], v5 offset:272
    v_cvt_pk_bf16_f32 v41, v10, v11
    v_lshlrev_b32 v8, 16, v42
    v_mfma_f32_16x16x32_bf16 v[92:95], a[20:23], a[180:183], v[92:95]
    v_and_b32 v9, s81, v42
    v_lshlrev_b32 v10, 16, v43
    v_and_b32 v11, s81, v43
    v_mfma_f32_16x16x32_bf16 v[80:83], a[24:27], a[184:187], v[80:83]
    s_add_u32 s57, s56, 24576
    buffer_load_dwordx4 a[12:15], v12, s[44:47], s57 offen offset:1040
    v_fmac_f32 v8, v164, v68
    v_fmac_f32 v9, v165, v69
    v_mfma_f32_16x16x32_bf16 v[88:91], a[24:27], a[188:191], v[88:91]
    v_fmac_f32 v10, v166, v70
    v_fmac_f32 v11, v167, v71
    v_cvt_pk_bf16_f32 v42, v8, v9
    v_mfma_f32_16x16x32_bf16 v[84:87], a[28:31], a[184:187], v[84:87]
    v_cvt_pk_bf16_f32 v43, v10, v11
    s_waitcnt lgkmcnt(3)
    v_lshlrev_b32 v8, 16, v44
    v_mfma_f32_16x16x32_bf16 v[92:95], a[28:31], a[188:191], v[92:95]
    v_and_b32 v9, s81, v44
    v_mfma_f32_16x16x32_bf16 v[48:51], a[32:35], a[160:163], v[24:27]
    ds_read_b128 v[32:35], v2 offset:33280
    s_add_u32 s57, s56, 24576
    buffer_load_dwordx4 a[16:19], v12, s[44:47], s57 offen offset:32
    ds_write_b128 v2, v[40:43] offset:64
    v_lshlrev_b32 v10, 16, v45
    v_mfma_f32_16x16x32_bf16 v[56:59], a[32:35], a[164:167], v[24:27]
    v_and_b32 v11, s81, v45
    v_fmac_f32 v8, v168, v72
    v_fmac_f32 v9, v169, v73
    v_fmac_f32 v10, v170, v74
    v_mfma_f32_16x16x32_bf16 v[52:55], a[36:39], a[160:163], v[28:31]
    v_fmac_f32 v11, v171, v75
    v_cvt_pk_bf16_f32 v44, v8, v9
    v_cvt_pk_bf16_f32 v45, v10, v11
    v_mfma_f32_16x16x32_bf16 v[60:63], a[36:39], a[164:167], v[28:31]
    v_lshlrev_b32 v8, 16, v46
    v_and_b32 v9, s81, v46
    v_mfma_f32_16x16x32_bf16 v[48:51], a[40:43], a[168:171], v[48:51]
    ds_read_b128 v[36:39], v2 offset:49920
    s_add_u32 s57, s56, 24576
    buffer_load_dwordx4 a[20:23], v12, s[44:47], s57 offen offset:1056
    s_mov_b32 m0, s58
    s_nop 0
    v_mfma_f32_16x16x32_bf16 v[56:59], a[40:43], a[172:175], v[56:59]
    buffer_load_dword v13, s[8:11], 0 offen sc0 sc1 lds
    v_lshlrev_b32 v10, 16, v47
    v_and_b32 v11, s81, v47
    v_fmac_f32 v8, v172, v76
    v_fmac_f32 v9, v173, v77
    v_mfma_f32_16x16x32_bf16 v[52:55], a[44:47], a[168:171], v[52:55]
    v_fmac_f32 v10, v174, v78
    v_fmac_f32 v11, v175, v79
    v_mfma_f32_16x16x32_bf16 v[60:63], a[44:47], a[172:175], v[60:63]
    v_cvt_pk_bf16_f32 v46, v8, v9
    v_cvt_pk_bf16_f32 v47, v10, v11
    v_mfma_f32_16x16x32_bf16 v[48:51], a[48:51], a[176:179], v[48:51]
    s_add_u32 s57, s56, 24576
    buffer_load_dwordx4 a[24:27], v12, s[44:47], s57 offen offset:48
    ds_write_b128 v2, v[44:47] offset:16704
    s_waitcnt lgkmcnt(3)
    v_lshlrev_b32 v8, 16, v32
    v_mfma_f32_16x16x32_bf16 v[56:59], a[48:51], a[180:183], v[56:59]
    v_and_b32 v9, s81, v32
    v_lshlrev_b32 v10, 16, v33
    v_and_b32 v11, s81, v33
    v_mfma_f32_16x16x32_bf16 v[52:55], a[52:55], a[176:179], v[52:55]
    v_fmac_f32 v8, v144, v80
    v_fmac_f32 v9, v145, v81
    v_mfma_f32_16x16x32_bf16 v[60:63], a[52:55], a[180:183], v[60:63]
    v_fmac_f32 v10, v146, v82
    v_fmac_f32 v11, v147, v83
    v_mfma_f32_16x16x32_bf16 v[48:51], a[56:59], a[184:187], v[48:51]
    s_add_u32 s57, s56, 24576
    buffer_load_dwordx4 a[28:31], v12, s[44:47], s57 offen offset:1072
    s_add_u32 s21, s21, 8192
    v_cvt_pk_bf16_f32 v32, v8, v9
    v_mfma_f32_16x16x32_bf16 v[56:59], a[56:59], a[188:191], v[56:59]
    v_cvt_pk_bf16_f32 v33, v10, v11
    v_lshlrev_b32 v8, 16, v34
    v_and_b32 v9, s81, v34
    v_lshlrev_b32 v10, 16, v35
    v_mfma_f32_16x16x32_bf16 v[52:55], a[60:63], a[184:187], v[52:55]
    v_and_b32 v11, s81, v35
    v_fmac_f32 v8, v148, v84
    v_mfma_f32_16x16x32_bf16 v[60:63], a[60:63], a[188:191], v[60:63]
    v_fmac_f32 v9, v149, v85
    v_fmac_f32 v10, v150, v86
    s_waitcnt vmcnt(25)
    v_mfma_f32_16x16x32_bf16 v[96:99], a[64:67], a[128:131], v[16:19]
    v_mfma_f32_16x16x32_bf16 v[104:107], a[64:67], a[132:135], v[16:19]
L_S2:
    ds_read_b64 v[14:15], v0 offset:0
    s_waitcnt lgkmcnt(0)
    v_xor_b32 v14, s80, v14
    v_xor_b32 v15, s80, v15
    v_or_b32 v14, v14, v15
    v_cmp_ne_u32 s[62:63], 0, v14
    ds_read_b64 v[14:15], v0 offset:8
    s_waitcnt lgkmcnt(0)
    v_xor_b32 v14, s80, v14
    v_xor_b32 v15, s80, v15
    v_or_b32 v14, v14, v15
    v_cmp_ne_u32 vcc, 0, v14
    s_nop 4
    s_or_b64 vcc, vcc, s[62:63]
    s_cbranch_scc0 L_F2
    s_add_u32 s57, s56, 131072
    buffer_load_dwordx4 a[32:35], v7, s[48:51], s57 offen offset:64
    v_fmac_f32 v11, v151, v87
    v_cvt_pk_bf16_f32 v34, v8, v9
    v_cvt_pk_bf16_f32 v35, v10, v11
    v_mfma_f32_16x16x32_bf16 v[100:103], a[68:71], a[128:131], v[20:23]
    ds_write_b128 v2, v[32:35] offset:33280
    v_lshlrev_b32 v8, 16, v36
    v_and_b32 v9, s81, v36
    v_mfma_f32_16x16x32_bf16 v[108:111], a[68:71], a[132:135], v[20:23]
    v_lshlrev_b32 v10, 16, v37
    v_and_b32 v11, s81, v37
    v_mfma_f32_16x16x32_bf16 v[96:99], a[72:75], a[136:139], v[96:99]
    s_add_u32 s57, s56, 135168
    buffer_load_dwordx4 a[36:39], v7, s[48:51], s57 offen offset:64
    s_mov_b32 m0, s58
    s_nop 0
    buffer_load_dword v13, s[8:11], 0 offen sc0 sc1 lds
    v_mfma_f32_16x16x32_bf16 v[104:107], a[72:75], a[140:143], v[104:107]
    v_fmac_f32 v8, v152, v88
    v_fmac_f32 v9, v153, v89
    v_fmac_f32 v10, v154, v90
    v_fmac_f32 v11, v155, v91
    v_mfma_f32_16x16x32_bf16 v[100:103], a[76:79], a[136:139], v[100:103]
    ds_read_b128 v[40:43], v2 offset:33344
    ds_read_b128 v[44:47], v2 offset:49984
    v_cvt_pk_bf16_f32 v36, v8, v9
    v_cvt_pk_bf16_f32 v37, v10, v11
    v_mfma_f32_16x16x32_bf16 v[108:111], a[76:79], a[140:143], v[108:111]
    v_lshlrev_b32 v8, 16, v38
    v_and_b32 v9, s81, v38
    v_lshlrev_b32 v10, 16, v39
    s_waitcnt vmcnt(23)
    v_mfma_f32_16x16x32_bf16 v[96:99], a[80:83], a[144:147], v[96:99]
    s_add_u32 s57, s56, 131072
    buffer_load_dwordx4 a[40:43], v7, s[48:51], s57 offen offset:80
    v_and_b32 v11, s81, v39
    v_mfma_f32_16x16x32_bf16 v[104:107], a[80:83], a[148:151], v[104:107]
    v_fmac_f32 v8, v156, v92
    v_fmac_f32 v9, v157, v93
    v_fmac_f32 v10, v158, v94
    v_mfma_f32_16x16x32_bf16 v[100:103], a[84:87], a[144:147], v[100:103]
    v_fmac_f32 v11, v159, v95
    v_cvt_pk_bf16_f32 v38, v8, v9
    v_mfma_f32_16x16x32_bf16 v[108:111], a[84:87], a[148:151], v[108:111]
    v_cvt_pk_bf16_f32 v39, v10, v11
    v_mfma_f32_16x16x32_bf16 v[96:99], a[88:91], a[152:155], v[96:99]
    s_add_u32 s57, s56, 135168
    buffer_load_dwordx4 a[44:47], v7, s[48:51], s57 offen offset:80
    ds_write_b128 v2, v[36:39] offset:49920
    s_waitcnt lgkmcnt(2)
    v_lshlrev_b32 v8, 16, v40
    v_mfma_f32_16x16x32_bf16 v[104:107], a[88:91], a[156:159], v[104:107]
    v_and_b32 v9, s81, v40
    v_lshlrev_b32 v10, 16, v41
    v_and_b32 v11, s81, v41
    v_mfma_f32_16x16x32_bf16 v[100:103], a[92:95], a[152:155], v[100:103]
    v_fmac_f32 v8, v176, v48
    v_fmac_f32 v9, v177, v49
    v_mfma_f32_16x16x32_bf16 v[108:111], a[92:95], a[156:159], v[108:111]
    v_fmac_f32 v10, v178, v50
    v_fmac_f32 v11, v179, v51
    v_mfma_f32_16x16x32_bf16 v[64:67], a[64:67], a[160:163], v[16:19]
    s_add_u32 s57, s56, 131072
    buffer_load_dwordx4 a[48:51], v7, s[48:51], s57 offen offset:96
    v_cvt_pk_bf16_f32 v40, v8, v9
    v_mfma_f32_16x16x32_bf16 v[72:75], a[64:67], a[164:167], v[16:19]
    v_cvt_pk_bf16_f32 v41, v10, v11
    v_lshlrev_b32 v8, 16, v42
    v_mfma_f32_16x16x32_bf16 v[68:71], a[68:71], a[160:163], v[20:23]
    v_and_b32 v9, s81, v42
    v_lshlrev_b32 v10, 16, v43
    v_mfma_f32_16x16x32_bf16 v[76:79], a[68:71], a[164:167], v[20:23]
    v_and_b32 v11, s81, v43
    v_fmac_f32 v8, v180, v52
    v_mfma_f32_16x16x32_bf16 v[64:67], a[72:75], a[168:171], v[64:67]
    s_waitcnt lgkmcnt(0)
    s_barrier
    ds_read_b128 a[192:195], v1 offset:0
    ds_read_b128 a[196:199], v1 offset:16640
    ds_read_b128 a[200:203], v1 offset:16
    ds_read_b128 a[204:207], v1 offset:16656
    s_add_u32 s57, s56, 135168
    buffer_load_dwordx4 a[52:55], v7, s[48:51], s57 offen offset:96
    v_mfma_f32_16x16x32_bf16 v[72:75], a[72:75], a[172:175], v[72:75]
    s_mov_b32 m0, s58
    s_nop 0
    buffer_load_dword v13, s[8:11], 0 offen sc0 sc1 lds
    v_fmac_f32 v9, v181, v53
    v_fmac_f32 v10, v182, v54
    v_fmac_f32 v11, v183, v55
    v_cvt_pk_bf16_f32 v42, v8, v9
    v_mfma_f32_16x16x32_bf16 v[68:71], a[76:79], a[168:171], v[68:71]
    v_cvt_pk_bf16_f32 v43, v10, v11
    v_lshlrev_b32 v8, 16, v44
    v_mfma_f32_16x16x32_bf16 v[76:79], a[76:79], a[172:175], v[76:79]
    v_and_b32 v9, s81, v44
    v_mfma_f32_16x16x32_bf16 v[64:67], a[80:83], a[176:179], v[64:67]
    ds_read_b128 a[208:211], v1 offset:32
    ds_read_b128 a[212:215], v1 offset:16672
    s_add_u32 s57, s56, 131072
    buffer_load_dwordx4 a[56:59], v7, s[48:51], s57 offen offset:112
    ds_write_b128 v2, v[40:43] offset:33344
    v_mfma_f32_16x16x32_bf16 v[72:75], a[80:83], a[180:183], v[72:75]
    v_lshlrev_b32 v10, 16, v45
    v_and_b32 v11, s81, v45
    v_fmac_f32 v8, v184, v56
    v_fmac_f32 v9, v185, v57
    v_mfma_f32_16x16x32_bf16 v[68:71], a[84:87], a[176:179], v[68:71]
    v_fmac_f32 v10, v186, v58
    v_fmac_f32 v11, v187, v59
    v_mfma_f32_16x16x32_bf16 v[76:79], a[84:87], a[180:183], v[76:79]
    v_cvt_pk_bf16_f32 v44, v8, v9
    v_cvt_pk_bf16_f32 v45, v10, v11
    v_mfma_f32_16x16x32_bf16 v[64:67], a[88:91], a[184:187], v[64:67]
    ds_read_b128 v[32:35], v2 offset:128
    ds_read_b128 a[216:219], v1 offset:48
    ds_read_b128 a[220:223], v1 offset:16688
    s_add_u32 s57, s56, 135168
    buffer_load_dwordx4 a[60:63], v7, s[48:51], s57 offen offset:112
    v_mfma_f32_16x16x32_bf16 v[72:75], a[88:91], a[188:191], v[72:75]
    s_add_u32 s21, s21, 8192
    v_lshlrev_b32 v8, 16, v46
    v_and_b32 v9, s81, v46
    v_lshlrev_b32 v10, 16, v47
    v_mfma_f32_16x16x32_bf16 v[68:71], a[92:95], a[184:187], v[68:71]
    ds_read_b128 v[36:39], v2 offset:16768
    v_and_b32 v11, s81, v47
    v_fmac_f32 v8, v188, v60
    v_mfma_f32_16x16x32_bf16 v[76:79], a[92:95], a[188:191], v[76:79]
    v_fmac_f32 v9, v189, v61
    v_fmac_f32 v10, v190, v62
    s_waitcnt vmcnt(25) lgkmcnt(7)
    v_mfma_f32_16x16x32_bf16 v[80:83], a[96:99], a[192:195], 0
    v_mfma_f32_16x16x32_bf16 v[88:91], a[96:99], a[196:199], 0
L_S3:
    ds_read_b64 v[14:15], v0 offset:0
    s_waitcnt lgkmcnt(0)
    v_xor_b32 v14, s80, v14
    v_xor_b32 v15, s80, v15
    v_or_b32 v14, v14, v15
    v_cmp_ne_u32 s[62:63], 0, v14
    ds_read_b64 v[14:15], v0 offset:8
    s_waitcnt lgkmcnt(0)
    v_xor_b32 v14, s80, v14
    v_xor_b32 v15, s80, v15
    v_or_b32 v14, v14, v15
    v_cmp_ne_u32 vcc, 0, v14
    s_nop 4
    s_or_b64 vcc, vcc, s[62:63]
    s_cbranch_scc0 L_F3
    ds_read_b128 a[224:227], v1 offset:33280
    ds_read_b128 a[228:231], v1 offset:49920
    s_add_u32 s57, s56, 131072
    buffer_load_dwordx4 a[64:67], v7, s[48:51], s57 offen offset:128
    v_fmac_f32 v11, v191, v63
    v_cvt_pk_bf16_f32 v46, v8, v9
    v_mfma_f32_16x16x32_bf16 v[84:87], a[100:103], a[192:195], 0
    v_cvt_pk_bf16_f32 v47, v10, v11
    v_mfma_f32_16x16x32_bf16 v[92:95], a[100:103], a[196:199], 0
    v_mfma_f32_16x16x32_bf16 v[80:83], a[104:107], a[200:203], v[80:83]
    ds_read_b128 v[16:19], v5 offset:384
    ds_read_b128 a[232:235], v1 offset:33296
    ds_read_b128 a[236:239], v1 offset:49936
    s_add_u32 s57, s56, 135168
    buffer_load_dwordx4 a[68:71], v7, s[48:51], s57 offen offset:128
    s_mov_b32 m0, s58
    v_mfma_f32_16x16x32_bf16 v[88:91], a[104:107], a[204:207], v[88:91]
    s_nop 0
    buffer_load_dword v13, s[8:11], 0 offen sc0 sc1 lds
    ds_write_b128 v2, v[44:47] offset:49984
    v_lshlrev_b32 v8, 16, v32
    v_and_b32 v9, s81, v32
    v_mfma_f32_16x16x32_bf16 v[84:87], a[108:111], a[200:203], v[84:87]
    v_lshlrev_b32 v10, 16, v33
    v_and_b32 v11, s81, v33
    v_mfma_f32_16x16x32_bf16 v[92:95], a[108:111], a[204:207], v[92:95]
    v_fmac_f32 v8, v192, v96
    s_waitcnt vmcnt(23)
    v_mfma_f32_16x16x32_bf16 v[80:83], a[112:115], a[208:211], v[80:83]
    ds_read_b128 a[240:243], v1 offset:33312
    ds_read_b128 a[244:247], v1 offset:49952
    s_add_u32 s57, s56, 131072
    v_mfma_f32_16x16x32_bf16 v[88:91], a[112:115], a[212:215], v[88:91]
    buffer_load_dwordx4 a[72:75], v7, s[48:51], s57 offen offset:144
    v_fmac_f32 v9, v193, v97
    v_fmac_f32 v10, v194, v98
    v_mfma_f32_16x16x32_bf16 v[84:87], a[116:119], a[208:211], v[84:87]
    ds_read_b128 v[20:23], v5 offset:400
    v_fmac_f32 v11, v195, v99
    v_mfma_f32_16x16x32_bf16 v[92:95], a[116:119], a[212:215], v[92:95]
    v_cvt_pk_bf16_f32 v32, v8, v9
    v_mfma_f32_16x16x32_bf16 v[80:83], a[120:123], a[216:219], v[80:83]
    ds_read_b128 a[248:251], v1 offset:33328
    ds_read_b128 a[252:255], v1 offset:49968
    s_add_u32 s57, s56, 135168
    buffer_load_dwordx4 a[76:79], v7, s[48:51], s57 offen offset:144
    v_mfma_f32_16x16x32_bf16 v[88:91], a[120:123], a[220:223], v[88:91]
    v_cvt_pk_bf16_f32 v33, v10, v11
    v_lshlrev_b32 v8, 16, v34
    v_and_b32 v9, s81, v34
    v_mfma_f32_16x16x32_bf16 v[84:87], a[124:127], a[216:219], v[84:87]
    v_lshlrev_b32 v10, 16, v35
    v_mfma_f32_16x16x32_bf16 v[92:95], a[124:127], a[220:223], v[92:95]
    v_and_b32 v11, s81, v35
    s_waitcnt lgkmcnt(6)
    v_mfma_f32_16x16x32_bf16 v[112:115], a[96:99], a[224:227], 0
    s_add_u32 s57, s56, 131072
    buffer_load_dwordx4 a[80:83], v7, s[48:51], s57 offen offset:160
    v_mfma_f32_16x16x32_bf16 v[120:123], a[96:99], a[228:231], 0
    v_fmac_f32 v8, v196, v100
    v_fmac_f32 v9, v197, v101
    v_mfma_f32_16x16x32_bf16 v[116:119], a[100:103], a[224:227], 0
    v_fmac_f32 v10, v198, v102
    v_fmac_f32 v11, v199, v103
    v_mfma_f32_16x16x32_bf16 v[124:127], a[100:103], a[228:231], 0
    v_cvt_pk_bf16_f32 v34, v8, v9
    v_mfma_f32_16x16x32_bf16 v[112:115], a[104:107], a[232:235], v[112:115]
    s_add_u32 s57, s56, 135168
    buffer_load_dwordx4 a[84:87], v7, s[48:51], s57 offen offset:160
    s_mov_b32 m0, s58
    v_mfma_f32_16x16x32_bf16 v[120:123], a[104:107], a[236:239], v[120:123]
    s_nop 0
    buffer_load_dword v13, s[8:11], 0 offen sc0 sc1 lds
    v_cvt_pk_bf16_f32 v35, v10, v11
    v_mfma_f32_16x16x32_bf16 v[116:119], a[108:111], a[232:235], v[116:119]
    ds_write_b128 v2, v[32:35] offset:128
    v_lshlrev_b32 v8, 16, v36
    v_mfma_f32_16x16x32_bf16 v[124:127], a[108:111], a[236:239], v[124:127]
    v_and_b32 v9, s81, v36
    s_waitcnt lgkmcnt(1)
    v_mfma_f32_16x16x32_bf16 v[112:115], a[112:115], a[240:243], v[112:115]
    s_add_u32 s57, s56, 131072
    buffer_load_dwordx4 a[88:91], v7, s[48:51], s57 offen offset:176
    v_lshlrev_b32 v10, 16, v37
    v_mfma_f32_16x16x32_bf16 v[120:123], a[112:115], a[244:247], v[120:123]
    v_and_b32 v11, s81, v37
    v_fmac_f32 v8, v200, v104
    v_mfma_f32_16x16x32_bf16 v[116:119], a[116:119], a[240:243], v[116:119]
    v_fmac_f32 v9, v201, v105
    v_mfma_f32_16x16x32_bf16 v[124:127], a[116:119], a[244:247], v[124:127]
    v_fmac_f32 v10, v202, v106
    v_mfma_f32_16x16x32_bf16 v[112:115], a[120:123], a[248:251], v[112:115]
    ds_read_b128 v[40:43], v2 offset:33408
    s_add_u32 s57, s56, 135168
    buffer_load_dwordx4 a[92:95], v7, s[48:51], s57 offen offset:176
    v_mfma_f32_16x16x32_bf16 v[120:123], a[120:123], a[252:255], v[120:123]
    s_add_u32 s21, s21, 8192
    v_fmac_f32 v11, v203, v107
    v_cvt_pk_bf16_f32 v36, v8, v9
    v_mfma_f32_16x16x32_bf16 v[116:119], a[124:127], a[248:251], v[116:119]
    ds_read_b128 v[44:47], v2 offset:50048
    v_cvt_pk_bf16_f32 v37, v10, v11
    v_mfma_f32_16x16x32_bf16 v[124:127], a[124:127], a[252:255], v[124:127]
    v_lshlrev_b32 v8, 16, v38
    v_and_b32 v9, s81, v38
    s_waitcnt vmcnt(25)
    v_mfma_f32_16x16x32_bf16 v[48:51], a[0:3], a[128:131], v[16:19]
    v_mfma_f32_16x16x32_bf16 v[56:59], a[0:3], a[132:135], v[16:19]
L_S4:
    ds_read_b64 v[14:15], v0 offset:0
    s_waitcnt lgkmcnt(0)
    v_xor_b32 v14, s80, v14
    v_xor_b32 v15, s80, v15
    v_or_b32 v14, v14, v15
    v_cmp_ne_u32 s[62:63], 0, v14
    ds_read_b64 v[14:15], v0 offset:8
    s_waitcnt lgkmcnt(0)
    v_xor_b32 v14, s80, v14
    v_xor_b32 v15, s80, v15
    v_or_b32 v14, v14, v15
    v_cmp_ne_u32 vcc, 0, v14
    s_nop 4
    s_or_b64 vcc, vcc, s[62:63]
    s_cbranch_scc0 L_F4
    s_add_u32 s57, s56, 131072
    buffer_load_dwordx4 a[96:99], v7, s[48:51], s57 offen offset:192
    v_lshlrev_b32 v10, 16, v39
    v_and_b32 v11, s81, v39
    v_fmac_f32 v8, v204, v108
    v_fmac_f32 v9, v205, v109
    v_mfma_f32_16x16x32_bf16 v[52:55], a[4:7], a[128:131], v[20:23]
    v_fmac_f32 v10, v206, v110
    v_fmac_f32 v11, v207, v111
    v_mfma_f32_16x16x32_bf16 v[60:63], a[4:7], a[132:135], v[20:23]
    v_cvt_pk_bf16_f32 v38, v8, v9
    v_cvt_pk_bf16_f32 v39, v10, v11
    v_mfma_f32_16x16x32_bf16 v[48:51], a[8:11], a[136:139], v[48:51]
    s_add_u32 s57, s56, 135168
    buffer_load_dwordx4 a[100:103], v7, s[48:51], s57 offen offset:192
    s_mov_b32 m0, s58
    s_nop 0
    buffer_load_dword v13, s[8:11], 0 offen sc0 sc1 lds
    v_mfma_f32_16x16x32_bf16 v[56:59], a[8:11], a[140:143], v[56:59]
    ds_write_b128 v2, v[36:39] offset:16768
    v_lshlrev_b32 v8, 16, v40
    v_and_b32 v9, s81, v40
    v_lshlrev_b32 v10, 16, v41
    v_mfma_f32_16x16x32_bf16 v[52:55], a[12:15], a[136:139], v[52:55]
    v_and_b32 v11, s81, v41
    v_fmac_f32 v8, v208, v64
    v_mfma_f32_16x16x32_bf16 v[60:63], a[12:15], a[140:143], v[60:63]
    v_fmac_f32 v9, v209, v65
    s_waitcnt vmcnt(23)
    v_mfma_f32_16x16x32_bf16 v[48:51], a[16:19], a[144:147], v[48:51]
    s_add_u32 s57, s56, 131072
    buffer_load_dwordx4 a[104:107], v7, s[48:51], s57 offen offset:208
    v_fmac_f32 v10, v210, v66
    v_mfma_f32_16x16x32_bf16 v[56:59], a[16:19], a[148:151], v[56:59]
    v_fmac_f32 v11, v211, v67
    v_cvt_pk_bf16_f32 v40, v8, v9
    v_mfma_f32_16x16x32_bf16 v[52:55], a[20:23], a[144:147], v[52:55]
    v_cvt_pk_bf16_f32 v41, v10, v11
    v_lshlrev_b32 v8, 16, v42
    v_mfma_f32_16x16x32_bf16 v[60:63], a[20:23], a[148:151], v[60:63]
    v_and_b32 v9, s81, v42
    v_mfma_f32_16x16x32_bf16 v[48:51], a[24:27], a[152:155], v[48:51]
    s_waitcnt lgkmcnt(0)
    s_barrier
    s_add_u32 s57, s56, 135168
    buffer_load_dwordx4 a[108:111], v7, s[48:51], s57 offen offset:208
    v_mfma_f32_16x16x32_bf16 v[56:59], a[24:27], a[156:159], v[56:59]
    v_lshlrev_b32 v10, 16, v43
    v_and_b32 v11, s81, v43
    v_fmac_f32 v8, v212, v68
    v_mfma_f32_16x16x32_bf16 v[52:55], a[28:31], a[152:155], v[52:55]
    v_fmac_f32 v9, v213, v69
    v_fmac_f32 v10, v214, v70
    v_mfma_f32_16x16x32_bf16 v[60:63], a[28:31], a[156:159], v[60:63]
    v_fmac_f32 v11, v215, v71
    v_mfma_f32_16x16x32_bf16 v[96:99], a[0:3], a[160:163], v[16:19]
    s_add_u32 s57, s56, 131072
    buffer_load_dwordx4 a[112:115], v7, s[48:51], s57 offen offset:224
    v_mfma_f32_16x16x32_bf16 v[104:107], a[0:3], a[164:167], v[16:19]
    v_cvt_pk_bf16_f32 v42, v8, v9
    v_cvt_pk_bf16_f32 v43, v10, v11
    v_mfma_f32_16x16x32_bf16 v[100:103], a[4:7], a[160:163], v[20:23]
    ds_read_b128 a[192:195], v1 offset:64
    ds_read_b128 a[196:199], v1 offset:16704
    ds_write_b128 v2, v[40:43] offset:33408
    v_mfma_f32_16x16x32_bf16 v[108:111], a[4:7], a[164:167], v[20:23]
    v_lshlrev_b32 v8, 16, v44
    v_and_b32 v9, s81, v44
    v_lshlrev_b32 v10, 16, v45
    v_mfma_f32_16x16x32_bf16 v[96:99], a[8:11], a[168:171], v[96:99]
    s_add_u32 s57, s56, 135168
    buffer_load_dwordx4 a[116:119], v7, s[48:51], s57 offen offset:224
    s_mov_b32 m0, s58
    s_nop 0
    buffer_load_dword v13, s[8:11], 0 offen sc0 sc1 lds
    v_mfma_f32_16x16x32_bf16 v[104:107], a[8:11], a[172:175], v[104:107]
    v_add_u32 v5, 2048, v5
    v_and_b32 v11, s81, v45
    v_fmac_f32 v8, v216, v72
    v_fmac_f32 v9, v217, v73
    v_mfma_f32_16x16x32_bf16 v[100:103], a[12:15], a[168:171], v[100:103]
    ds_read_b128 a[200:203], v1 offset:80
    ds_read_b128 a[204:207], v1 offset:16720
    v_fmac_f32 v10, v218, v74
    v_mfma_f32_16x16x32_bf16 v[108:111], a[12:15], a[172:175], v[108:111]
    v_fmac_f32 v11, v219, v75
    v_cvt_pk_bf16_f32 v44, v8, v9
    v_mfma_f32_16x16x32_bf16 v[96:99], a[16:19], a[176:179], v[96:99]
    ds_read_b128 v[32:35], v2 offset:192
    ds_read_b128 a[208:211], v1 offset:96
    ds_read_b128 a[212:215], v1 offset:16736
    s_add_u32 s57, s56, 131072
    v_mfma_f32_16x16x32_bf16 v[104:107], a[16:19], a[180:183], v[104:107]
    buffer_load_dwordx4 a[120:123], v7, s[48:51], s57 offen offset:240
    v_cvt_pk_bf16_f32 v45, v10, v11
    v_lshlrev_b32 v8, 16, v46
    v_and_b32 v9, s81, v46
    v_mfma_f32_16x16x32_bf16 v[100:103], a[20:23], a[176:179], v[100:103]
    ds_read_b128 v[36:39], v2 offset:16832
    v_lshlrev_b32 v10, 16, v47
    v_mfma_f32_16x16x32_bf16 v[108:111], a[20:23], a[180:183], v[108:111]
    v_and_b32 v11, s81, v47
    v_fmac_f32 v8, v220, v76
    v_mfma_f32_16x16x32_bf16 v[96:99], a[24:27], a[184:187], v[96:99]
    ds_read_b128 a[216:219], v1 offset:112
    ds_read_b128 a[220:223], v1 offset:16752
    s_add_u32 s57, s56, 135168
    buffer_load_dwordx4 a[124:127], v7, s[48:51], s57 offen offset:240
    v_mfma_f32_16x16x32_bf16 v[104:107], a[24:27], a[188:191], v[104:107]
    s_add_u32 s21, s21, 8192
    v_fmac_f32 v9, v221, v77
    v_fmac_f32 v10, v222, v78
    v_fmac_f32 v11, v223, v79
    v_mfma_f32_16x16x32_bf16 v[100:103], a[28:31], a[184:187], v[100:103]
    v_cvt_pk_bf16_f32 v46, v8, v9
    v_mfma_f32_16x16x32_bf16 v[108:111], a[28:31], a[188:191], v[108:111]
    v_cvt_pk_bf16_f32 v47, v10, v11
    s_waitcnt vmcnt(25) lgkmcnt(6)
    v_mfma_f32_16x16x32_bf16 v[80:83], a[32:35], a[192:195], v[80:83]
    v_mfma_f32_16x16x32_bf16 v[88:91], a[32:35], a[196:199], v[88:91]
L_S5:
    ds_read_b64 v[14:15], v0 offset:0
    s_waitcnt lgkmcnt(0)
    v_xor_b32 v14, s80, v14
    v_xor_b32 v15, s80, v15
    v_or_b32 v14, v14, v15
    v_cmp_ne_u32 s[62:63], 0, v14
    ds_read_b64 v[14:15], v0 offset:8
    s_waitcnt lgkmcnt(0)
    v_xor_b32 v14, s80, v14
    v_xor_b32 v15, s80, v15
    v_or_b32 v14, v14, v15
    v_cmp_ne_u32 vcc, 0, v14
    s_nop 4
    s_or_b64 vcc, vcc, s[62:63]
    s_cbranch_scc0 L_F5
    ds_read_b128 a[224:227], v1 offset:33344
    ds_read_b128 a[228:231], v1 offset:49984
    s_add_u32 s57, s56, 131072
    buffer_load_dwordx4 a[0:3], v12, s[44:47], s57 offen offset:0
    ds_write_b128 v2, v[44:47] offset:50048
    v_lshlrev_b32 v8, 16, v32
    v_and_b32 v9, s81, v32
    v_lshlrev_b32 v10, 16, v33
    v_mfma_f32_16x16x32_bf16 v[84:87], a[36:39], a[192:195], v[84:87]
    v_and_b32 v11, s81, v33
    v_fmac_f32 v8, v224, v48
    v_mfma_f32_16x16x32_bf16 v[92:95], a[36:39], a[196:199], v[92:95]
    v_fmac_f32 v9, v225, v49
    v_mfma_f32_16x16x32_bf16 v[80:83], a[40:43], a[200:203], v[80:83]
    ds_read_b128 a[232:235], v1 offset:33360
    ds_read_b128 a[236:239], v1 offset:50000
    s_add_u32 s57, s56, 131072
    buffer_load_dwordx4 a[4:7], v12, s[44:47], s57 offen offset:1024
    s_mov_b32 m0, s58
    v_mfma_f32_16x16x32_bf16 v[88:91], a[40:43], a[204:207], v[88:91]
    s_nop 0
    buffer_load_dword v13, s[8:11], 0 offen sc0 sc1 lds
    v_fmac_f32 v10, v226, v50
    v_fmac_f32 v11, v227, v51
    v_mfma_f32_16x16x32_bf16 v[84:87], a[44:47], a[200:203], v[84:87]
    v_cvt_pk_bf16_f32 v32, v8, v9
    v_cvt_pk_bf16_f32 v33, v10, v11
    v_mfma_f32_16x16x32_bf16 v[92:95], a[44:47], a[204:207], v[92:95]
    v_lshlrev_b32 v8, 16, v34
    s_waitcnt vmcnt(23)
    v_mfma_f32_16x16x32_bf16 v[80:83], a[48:51], a[208:211], v[80:83]
    ds_read_b128 a[240:243], v1 offset:33376
    ds_read_b128 a[244:247], v1 offset:50016
    s_add_u32 s57, s56, 131072
    buffer_load_dwordx4 a[8:11], v12, s[44:47], s57 offen offset:16
    v_mfma_f32_16x16x32_bf16 v[88:91], a[48:51], a[212:215], v[88:91]
    v_and_b32 v9, s81, v34
    v_lshlrev_b32 v10, 16, v35
    v_and_b32 v11, s81, v35
    v_mfma_f32_16x16x32_bf16 v[84:87], a[52:55], a[208:211], v[84:87]
    v_fmac_f32 v8, v228, v52
    v_fmac_f32 v9, v229, v53
    v_mfma_f32_16x16x32_bf16 v[92:95], a[52:55], a[212:215], v[92:95]
    v_fmac_f32 v10, v230, v54
    v_mfma_f32_16x16x32_bf16 v[80:83], a[56:59], a[216:219], v[80:83]
    ds_read_b128 a[248:251], v1 offset:33392
    ds_read_b128 a[252:255], v1 offset:50032
    s_add_u32 s57, s56, 131072
    buffer_load_dwordx4 a[12:15], v12, s[44:47], s57 offen offset:1040
    v_mfma_f32_16x16x32_bf16 v[88:91], a[56:59], a[220:223], v[88:91]
    v_fmac_f32 v11, v231, v55
    v_cvt_pk_bf16_f32 v34, v8, v9
    v_cvt_pk_bf16_f32 v35, v10, v11
    v_mfma_f32_16x16x32_bf16 v[84:87], a[60:63], a[216:219], v[84:87]
    ds_write_b128 v2, v[32:35] offset:192
    v_mfma_f32_16x16x32_bf16 v[92:95], a[60:63], a[220:223], v[92:95]
    v_lshlrev_b32 v8, 16, v36
    s_waitcnt lgkmcnt(5)
    v_mfma_f32_16x16x32_bf16 v[112:115], a[32:35], a[224:227], v[112:115]
    s_add_u32 s57, s56, 131072
    buffer_load_dwordx4 a[16:19], v12, s[44:47], s57 offen offset:32
    v_and_b32 v9, s81, v36
    v_mfma_f32_16x16x32_bf16 v[120:123], a[32:35], a[228:231], v[120:123]
    v_lshlrev_b32 v10, 16, v37
    v_and_b32 v11, s81, v37
    v_mfma_f32_16x16x32_bf16 v[116:119], a[36:39], a[224:227], v[116:119]
    ds_read_b128 a[192:195], v1 offset:128
    ds_read_b128 a[196:199], v1 offset:16768
    v_fmac_f32 v8, v232, v56
    v_mfma_f32_16x16x32_bf16 v[124:127], a[36:39], a[228:231], v[124:127]
    v_fmac_f32 v9, v233, v57
    v_fmac_f32 v10, v234, v58
    v_mfma_f32_16x16x32_bf16 v[112:115], a[40:43], a[232:235], v[112:115]
    ds_read_b128 a[200:203], v1 offset:144
    ds_read_b128 a[204:207], v1 offset:16784
    s_add_u32 s57, s56, 131072
    buffer_load_dwordx4 a[20:23], v12, s[44:47], s57 offen offset:1056
    s_mov_b32 m0, s58
    v_mfma_f32_16x16x32_bf16 v[120:123], a[40:43], a[236:239], v[120:123]
    s_nop 0
    buffer_load_dword v13, s[8:11], 0 offen sc0 sc1 lds
    v_fmac_f32 v11, v235, v59
    v_cvt_pk_bf16_f32 v36, v8, v9
    v_cvt_pk_bf16_f32 v37, v10, v11
    v_mfma_f32_16x16x32_bf16 v[116:119], a[44:47], a[232:235], v[116:119]
    ds_read_b128 v[40:43], v2 offset:33472
    v_lshlrev_b32 v8, 16, v38
    v_mfma_f32_16x16x32_bf16 v[124:127], a[44:47], a[236:239], v[124:127]
    v_and_b32 v9, s81, v38
    v_lshlrev_b32 v10, 16, v39
    s_waitcnt lgkmcnt(6)
    v_mfma_f32_16x16x32_bf16 v[112:115], a[48:51], a[240:243], v[112:115]
    ds_read_b128 v[44:47], v2 offset:50112
    ds_read_b128 a[208:211], v1 offset:160
    ds_read_b128 a[212:215], v1 offset:16800
    s_add_u32 s57, s56, 131072
    v_mfma_f32_16x16x32_bf16 v[120:123], a[48:51], a[244:247], v[120:123]
    buffer_load_dwordx4 a[24:27], v12, s[44:47], s57 offen offset:48
    v_and_b32 v11, s81, v39
    v_fmac_f32 v8, v236, v60
    v_mfma_f32_16x16x32_bf16 v[116:119], a[52:55], a[240:243], v[116:119]
    v_fmac_f32 v9, v237, v61
    v_fmac_f32 v10, v238, v62
    v_mfma_f32_16x16x32_bf16 v[124:127], a[52:55], a[244:247], v[124:127]
    v_fmac_f32 v11, v239, v63
    v_mfma_f32_16x16x32_bf16 v[112:115], a[56:59], a[248:251], v[112:115]
    s_add_u32 s57, s56, 131072
    buffer_load_dwordx4 a[28:31], v12, s[44:47], s57 offen offset:1072
    s_add_u32 s21, s21, 8192
    v_mfma_f32_16x16x32_bf16 v[120:123], a[56:59], a[252:255], v[120:123]
    v_cvt_pk_bf16_f32 v38, v8, v9
    v_cvt_pk_bf16_f32 v39, v10, v11
    v_mfma_f32_16x16x32_bf16 v[116:119], a[60:63], a[248:251], v[116:119]
    ds_read_b128 a[216:219], v1 offset:176
    ds_read_b128 a[220:223], v1 offset:16816
    ds_write_b128 v2, v[36:39] offset:16832
    v_mfma_f32_16x16x32_bf16 v[124:127], a[60:63], a[252:255], v[124:127]
    s_waitcnt lgkmcnt(6)
    v_lshlrev_b32 v8, 16, v40
    v_and_b32 v9, s81, v40
    v_lshlrev_b32 v10, 16, v41
    s_waitcnt vmcnt(25)
    v_mfma_f32_16x16x32_bf16 v[80:83], a[64:67], a[192:195], v[80:83]
    v_mfma_f32_16x16x32_bf16 v[88:91], a[64:67], a[196:199], v[88:91]
L_S6:
    ds_read_b64 v[14:15], v0 offset:0
    s_waitcnt lgkmcnt(0)
    v_xor_b32 v14, s80, v14
    v_xor_b32 v15, s80, v15
    v_or_b32 v14, v14, v15
    v_cmp_ne_u32 s[62:63], 0, v14
    ds_read_b64 v[14:15], v0 offset:8
    s_waitcnt lgkmcnt(0)
    v_xor_b32 v14, s80, v14
    v_xor_b32 v15, s80, v15
    v_or_b32 v14, v14, v15
    v_cmp_ne_u32 vcc, 0, v14
    s_nop 4
    s_or_b64 vcc, vcc, s[62:63]
    s_cbranch_scc0 L_F6
    s_add_u32 s57, s56, 139264
    buffer_load_dwordx4 a[32:35], v12, s[44:47], s57 offen offset:0
    v_and_b32 v11, s81, v41
    v_fmac_f32 v8, v240, v96
    v_fmac_f32 v9, v241, v97
    v_mfma_f32_16x16x32_bf16 v[84:87], a[68:71], a[192:195], v[84:87]
    v_fmac_f32 v10, v242, v98
    v_fmac_f32 v11, v243, v99
    v_mfma_f32_16x16x32_bf16 v[92:95], a[68:71], a[196:199], v[92:95]
    v_cvt_pk_bf16_f32 v40, v8, v9
    v_mfma_f32_16x16x32_bf16 v[80:83], a[72:75], a[200:203], v[80:83]
    s_add_u32 s57, s56, 139264
    buffer_load_dwordx4 a[36:39], v12, s[44:47], s57 offen offset:1024
    s_mov_b32 m0, s58
    s_nop 0
    v_mfma_f32_16x16x32_bf16 v[88:91], a[72:75], a[204:207], v[88:91]
    buffer_load_dword v13, s[8:11], 0 offen sc0 sc1 lds
    v_cvt_pk_bf16_f32 v41, v10, v11
    v_lshlrev_b32 v8, 16, v42
    v_and_b32 v9, s81, v42
    v_mfma_f32_16x16x32_bf16 v[84:87], a[76:79], a[200:203], v[84:87]
    s_barrier
    ds_read_b128 a[224:227], v1 offset:192
    ds_read_b128 a[228:231], v1 offset:16832
    ds_read_b128 a[232:235], v1 offset:208
    v_mfma_f32_16x16x32_bf16 v[92:95], a[76:79], a[204:207], v[92:95]
    ds_read_b128 a[236:239], v1 offset:16848
    v_lshlrev_b32 v10, 16, v43
    v_and_b32 v11, s81, v43
    v_fmac_f32 v8, v244, v100
    s_waitcnt vmcnt(23)
    v_mfma_f32_16x16x32_bf16 v[80:83], a[80:83], a[208:211], v[80:83]
    ds_read_b128 a[240:243], v1 offset:224
    ds_read_b128 a[244:247], v1 offset:16864
    s_add_u32 s57, s56, 139264
    buffer_load_dwordx4 a[40:43], v12, s[44:47], s57 offen offset:16
    v_mfma_f32_16x16x32_bf16 v[88:91], a[80:83], a[212:215], v[88:91]
    v_fmac_f32 v9, v245, v101
    v_fmac_f32 v10, v246, v102
    v_fmac_f32 v11, v247, v103
    v_mfma_f32_16x16x32_bf16 v[84:87], a[84:87], a[208:211], v[84:87]
    v_cvt_pk_bf16_f32 v42, v8, v9
    v_mfma_f32_16x16x32_bf16 v[92:95], a[84:87], a[212:215], v[92:95]
    v_cvt_pk_bf16_f32 v43, v10, v11
    v_mfma_f32_16x16x32_bf16 v[80:83], a[88:91], a[216:219], v[80:83]
    ds_read_b128 a[248:251], v1 offset:240
    ds_read_b128 a[252:255], v1 offset:16880
    s_add_u32 s57, s56, 139264
    buffer_load_dwordx4 a[44:47], v12, s[44:47], s57 offen offset:1040
    v_mfma_f32_16x16x32_bf16 v[88:91], a[88:91], a[220:223], v[88:91]
    ds_write_b128 v2, v[40:43] offset:33472
    v_lshlrev_b32 v8, 16, v44
    v_and_b32 v9, s81, v44
    v_lshlrev_b32 v10, 16, v45
    v_mfma_f32_16x16x32_bf16 v[84:87], a[92:95], a[216:219], v[84:87]
    v_and_b32 v11, s81, v45
    v_fmac_f32 v8, v248, v104
    v_mfma_f32_16x16x32_bf16 v[92:95], a[92:95], a[220:223], v[92:95]
    v_fmac_f32 v9, v249, v105
    s_waitcnt vmcnt(20) lgkmcnt(5)
    v_mfma_f32_16x16x32_bf16 v[80:83], a[96:99], a[224:227], v[80:83]
    ds_read_b128 a[192:195], v1 offset:33408
    ds_read_b128 a[196:199], v1 offset:50048
    s_add_u32 s57, s56, 139264
    buffer_load_dwordx4 a[48:51], v12, s[44:47], s57 offen offset:32
    v_mfma_f32_16x16x32_bf16 v[88:91], a[96:99], a[228:231], v[88:91]
    v_fmac_f32 v10, v250, v106
    v_fmac_f32 v11, v251, v107
    v_cvt_pk_bf16_f32 v44, v8, v9
    v_mfma_f32_16x16x32_bf16 v[84:87], a[100:103], a[224:227], v[84:87]
    v_cvt_pk_bf16_f32 v45, v10, v11
    v_lshlrev_b32 v8, 16, v46
    v_mfma_f32_16x16x32_bf16 v[92:95], a[100:103], a[228:231], v[92:95]
    v_and_b32 v9, s81, v46
    v_mfma_f32_16x16x32_bf16 v[80:83], a[104:107], a[232:235], v[80:83]
    ds_read_b128 a[200:203], v1 offset:33424
    ds_read_b128 a[204:207], v1 offset:50064
    s_add_u32 s57, s56, 139264
    buffer_load_dwordx4 a[52:55], v12, s[44:47], s57 offen offset:1056
    s_mov_b32 m0, s58
    v_mfma_f32_16x16x32_bf16 v[88:91], a[104:107], a[236:239], v[88:91]
    s_nop 0
    buffer_load_dword v13, s[8:11], 0 offen sc0 sc1 lds
    v_lshlrev_b32 v10, 16, v47
    v_and_b32 v11, s81, v47
    v_fmac_f32 v8, v252, v108
    v_mfma_f32_16x16x32_bf16 v[84:87], a[108:111], a[232:235], v[84:87]
    v_fmac_f32 v9, v253, v109
    v_fmac_f32 v10, v254, v110
    v_mfma_f32_16x16x32_bf16 v[92:95], a[108:111], a[236:239], v[92:95]
    v_fmac_f32 v11, v255, v111
    s_waitcnt vmcnt(18) lgkmcnt(5)
    v_mfma_f32_16x16x32_bf16 v[80:83], a[112:115], a[240:243], v[80:83]
    s_add_u32 s57, s56, 139264
    buffer_load_dwordx4 a[56:59], v12, s[44:47], s57 offen offset:48
    v_mfma_f32_16x16x32_bf16 v[88:91], a[112:115], a[244:247], v[88:91]
    v_cvt_pk_bf16_f32 v46, v8, v9
    v_cvt_pk_bf16_f32 v47, v10, v11
    v_mfma_f32_16x16x32_bf16 v[84:87], a[116:119], a[240:243], v[84:87]
    ds_read_b128 a[208:211], v1 offset:33440
    ds_read_b128 a[212:215], v1 offset:50080
    v_mfma_f32_16x16x32_bf16 v[92:95], a[116:119], a[244:247], v[92:95]
    ds_write_b128 v2, v[44:47] offset:50112
    v_mfma_f32_16x16x32_bf16 v[80:83], a[120:123], a[248:251], v[80:83]
    s_add_u32 s57, s56, 139264
    buffer_load_dwordx4 a[60:63], v12, s[44:47], s57 offen offset:1072
    v_mfma_f32_16x16x32_bf16 v[88:91], a[120:123], a[252:255], v[88:91]
    s_add_u32 s21, s21, 8192
    v_mfma_f32_16x16x32_bf16 v[84:87], a[124:127], a[248:251], v[84:87]
    ds_read_b128 a[216:219], v1 offset:33456
    v_mfma_f32_16x16x32_bf16 v[92:95], a[124:127], a[252:255], v[92:95]
    ds_read_b128 a[220:223], v1 offset:50096
    s_waitcnt lgkmcnt(5)
    v_mfma_f32_16x16x32_bf16 v[112:115], a[64:67], a[192:195], v[112:115]
    v_mfma_f32_16x16x32_bf16 v[120:123], a[64:67], a[196:199], v[120:123]
L_S7:
    ds_read_b64 v[14:15], v0 offset:0
    s_waitcnt lgkmcnt(0)
    v_xor_b32 v14, s80, v14
    v_xor_b32 v15, s80, v15
    v_or_b32 v14, v14, v15
    v_cmp_ne_u32 s[62:63], 0, v14
    ds_read_b64 v[14:15], v0 offset:8
    s_waitcnt lgkmcnt(0)
    v_xor_b32 v14, s80, v14
    v_xor_b32 v15, s80, v15
    v_or_b32 v14, v14, v15
    v_cmp_ne_u32 vcc, 0, v14
    s_nop 4
    s_or_b64 vcc, vcc, s[62:63]
    s_cbranch_scc0 L_F7
    s_add_u32 s57, s56, 147456
    buffer_load_dwordx4 a[64:67], v12, s[44:47], s57 offen offset:0
    v_mfma_f32_16x16x32_bf16 v[116:119], a[68:71], a[192:195], v[116:119]
    s_barrier
    ds_read_b128 a[224:227], v1 offset:33472
    v_mfma_f32_16x16x32_bf16 v[124:127], a[68:71], a[196:199], v[124:127]
    ds_read_b128 a[228:231], v1 offset:50112
    v_mfma_f32_16x16x32_bf16 v[112:115], a[72:75], a[200:203], v[112:115]
    ds_read_b128 a[232:235], v1 offset:33488
    ds_read_b128 a[236:239], v1 offset:50128
    s_add_u32 s57, s56, 147456
    buffer_load_dwordx4 a[68:71], v12, s[44:47], s57 offen offset:1024
    s_mov_b32 m0, s58
    s_nop 0
    v_mfma_f32_16x16x32_bf16 v[120:123], a[72:75], a[204:207], v[120:123]
    buffer_load_dword v13, s[8:11], 0 offen sc0 sc1 lds
    v_cvt_pk_bf16_f32 v80, v80, v81
    v_cvt_pk_bf16_f32 v81, v82, v83
    v_cvt_pk_bf16_f32 v82, v84, v85
    v_cvt_pk_bf16_f32 v83, v86, v87
    v_mfma_f32_16x16x32_bf16 v[116:119], a[76:79], a[200:203], v[116:119]
    ds_write_b128 v4, v[80:83] offset:0
    v_cvt_pk_bf16_f32 v84, v88, v89
    v_cvt_pk_bf16_f32 v85, v90, v91
    v_mfma_f32_16x16x32_bf16 v[124:127], a[76:79], a[204:207], v[124:127]
    v_cvt_pk_bf16_f32 v86, v92, v93
    v_cvt_pk_bf16_f32 v87, v94, v95
    v_mfma_f32_16x16x32_bf16 v[112:115], a[80:83], a[208:211], v[112:115]
    s_add_u32 s57, s56, 147456
    v_mfma_f32_16x16x32_bf16 v[120:123], a[80:83], a[212:215], v[120:123]
    buffer_load_dwordx4 a[72:75], v12, s[44:47], s57 offen offset:16
    v_mfma_f32_16x16x32_bf16 v[116:119], a[84:87], a[208:211], v[116:119]
    ds_read_b128 a[240:243], v1 offset:33504
    ds_read_b128 a[244:247], v1 offset:50144
    ds_read_b128 v[16:19], v5 offset:0
    v_mfma_f32_16x16x32_bf16 v[124:127], a[84:87], a[212:215], v[124:127]
    ds_read_b128 v[20:23], v5 offset:16
    ds_write_b128 v4, v[84:87] offset:1280
    v_mfma_f32_16x16x32_bf16 v[112:115], a[88:91], a[216:219], v[112:115]
    s_add_u32 s57, s56, 147456
    v_mfma_f32_16x16x32_bf16 v[120:123], a[88:91], a[220:223], v[120:123]
    buffer_load_dwordx4 a[76:79], v12, s[44:47], s57 offen offset:1040
    v_mfma_f32_16x16x32_bf16 v[116:119], a[92:95], a[216:219], v[116:119]
    s_waitcnt lgkmcnt(0)
    s_barrier
    ds_read_b128 a[248:251], v1 offset:33520
    v_mfma_f32_16x16x32_bf16 v[124:127], a[92:95], a[220:223], v[124:127]
    ds_read_b128 a[252:255], v1 offset:50160
    v_mfma_f32_16x16x32_bf16 v[112:115], a[96:99], a[224:227], v[112:115]
    ds_read_b128 a[128:131], v3 offset:0
    ds_read_b128 a[132:135], v3 offset:1280
    v_mfma_f32_16x16x32_bf16 v[120:123], a[96:99], a[228:231], v[120:123]
    s_add_u32 s57, s56, 147456
    buffer_load_dwordx4 a[80:83], v12, s[44:47], s57 offen offset:32
    v_mfma_f32_16x16x32_bf16 v[116:119], a[100:103], a[224:227], v[116:119]
    ds_read_b128 a[136:139], v3 offset:16
    v_mfma_f32_16x16x32_bf16 v[124:127], a[100:103], a[228:231], v[124:127]
    v_mfma_f32_16x16x32_bf16 v[112:115], a[104:107], a[232:235], v[112:115]
    ds_read_b128 a[140:143], v3 offset:1296
    s_add_u32 s57, s56, 147456
    buffer_load_dwordx4 a[84:87], v12, s[44:47], s57 offen offset:1056
    v_mfma_f32_16x16x32_bf16 v[120:123], a[104:107], a[236:239], v[120:123]
    s_mov_b32 m0, s58
    s_nop 0
    buffer_load_dword v13, s[8:11], 0 offen sc0 sc1 lds
    v_mfma_f32_16x16x32_bf16 v[116:119], a[108:111], a[232:235], v[116:119]
    ds_read_b128 a[144:147], v3 offset:32
    v_mfma_f32_16x16x32_bf16 v[124:127], a[108:111], a[236:239], v[124:127]
    s_waitcnt lgkmcnt(5)
    v_mfma_f32_16x16x32_bf16 v[112:115], a[112:115], a[240:243], v[112:115]
    ds_read_b128 a[148:151], v3 offset:1312
    s_add_u32 s57, s56, 147456
    v_mfma_f32_16x16x32_bf16 v[120:123], a[112:115], a[244:247], v[120:123]
    buffer_load_dwordx4 a[88:91], v12, s[44:47], s57 offen offset:48
    v_mfma_f32_16x16x32_bf16 v[116:119], a[116:119], a[240:243], v[116:119]
    ds_read_b128 a[152:155], v3 offset:48
    v_mfma_f32_16x16x32_bf16 v[124:127], a[116:119], a[244:247], v[124:127]
    v_mfma_f32_16x16x32_bf16 v[112:115], a[120:123], a[248:251], v[112:115]
    ds_read_b128 a[156:159], v3 offset:1328
    s_add_u32 s57, s56, 147456
    v_mfma_f32_16x16x32_bf16 v[120:123], a[120:123], a[252:255], v[120:123]
    buffer_load_dwordx4 a[92:95], v12, s[44:47], s57 offen offset:1072
    s_add_u32 s21, s21, 8192
    v_mfma_f32_16x16x32_bf16 v[116:119], a[124:127], a[248:251], v[116:119]
    v_mfma_f32_16x16x32_bf16 v[124:127], a[124:127], a[252:255], v[124:127]
    s_add_u32 s22, s22, 1
    s_add_u32 s56, s56, 131072
    s_cmp_lt_u32 s22, 5
    s_cbranch_scc1 L_Stop
    s_add_u32 s57, s56, 24576
    buffer_load_dwordx4 a[96:99], v12, s[44:47], s57 offen offset:0
    s_add_u32 s57, s56, 24576
    buffer_load_dwordx4 a[100:103], v12, s[44:47], s57 offen offset:1024
    s_mov_b32 m0, s58
    s_nop 0
    buffer_load_dword v13, s[8:11], 0 offen sc0 sc1 lds
    s_add_u32 s57, s56, 24576
    buffer_load_dwordx4 a[104:107], v12, s[44:47], s57 offen offset:16
    s_add_u32 s57, s56, 24576
    buffer_load_dwordx4 a[108:111], v12, s[44:47], s57 offen offset:1040
    s_add_u32 s57, s56, 24576
    buffer_load_dwordx4 a[112:115], v12, s[44:47], s57 offen offset:32
    s_add_u32 s57, s56, 24576
    buffer_load_dwordx4 a[116:119], v12, s[44:47], s57 offen offset:1056
    s_mov_b32 m0, s58
    s_nop 0
    buffer_load_dword v13, s[8:11], 0 offen sc0 sc1 lds
    s_add_u32 s57, s56, 24576
    buffer_load_dwordx4 a[120:123], v12, s[44:47], s57 offen offset:48
    s_add_u32 s57, s56, 24576
    buffer_load_dwordx4 a[124:127], v12, s[44:47], s57 offen offset:1072
    s_add_u32 s21, s21, 8192
    s_branch L_fin
.section .rodata,"a"
.p2align 6
.amdhsa_kernel standalone__cross_network_dcn_v2__recsys_kernel
  .amdhsa_next_free_vgpr 512
  .amdhsa_next_free_sgpr 102
  .amdhsa_accum_offset 256
  .amdhsa_group_segment_fixed_size 0
  .amdhsa_kernarg_size 56
  .amdhsa_user_sgpr_count 2
  .amdhsa_user_sgpr_kernarg_segment_ptr 1
  .amdhsa_system_sgpr_workgroup_id_x 1
.end_amdhsa_kernel
```
